```python
import torch

def _softmax(x, axis=-1):
    return torch.softmax(x, dim=axis)
def _gelu(x):
    return torch.nn.functional.gelu(x, approximate="tanh")
def _silu(x):
    return torch.nn.functional.silu(x)
def _sigmoid(x):
    return torch.sigmoid(x)
def _layernorm(x, axis=-1, eps=1e-5):
    m = x.mean(dim=axis, keepdim=True)
    v = x.var(dim=axis, keepdim=True, unbiased=False)
    return (x - m) / torch.sqrt(v + eps)
def _scatter_add(tgt, idx, src, axis=0):
    return tgt.clone().index_add_(axis, idx, src)
def _segment_sum(src, seg, n):
    out = torch.zeros((n,) + src.shape[1:], dtype=src.dtype)
    return out.index_add_(0, seg, src)
def _pad(x, pw):
    flat = tuple(v for pair in reversed(pw) for v in pair)
    return torch.nn.functional.pad(x, flat)

kernel_name = 'sequential_preLN__compressed_kv_cla__geglu_ffn__decode'

def setup_inputs():

    _w = (lambda a: (lambda t: t.to(torch.bfloat16) if t.is_floating_point() else t)(torch.as_tensor(a)))
    def _A_setup():
        B, H, Sq, Sk, D, M = 4, 32, 1, 4096, 128, 512
        Dc = 4 * D
        return {
            "x": _w((lambda *s: torch.randn(*s, dtype=torch.bfloat16) * 0.05)(B, Sq, M)),
            "c_kv": _w((lambda *s: torch.randn(*s, dtype=torch.bfloat16) * 0.4)(B, Sk, Dc)),
            "w_q": _w((lambda *s: torch.randn(*s, dtype=torch.bfloat16) * 3.2)(M, H, D) * (M ** -0.5)),
            "w_uk": _w((lambda *s: torch.randn(*s, dtype=torch.bfloat16) * 3.2)(Dc, H, D) * (Dc ** -0.5)),
            "w_uv": _w((lambda *s: torch.randn(*s, dtype=torch.bfloat16) * 0.4)(Dc, H, D) * (Dc ** -0.5)),
            "w_o": _w((lambda *s: torch.randn(*s, dtype=torch.bfloat16) * 0.4)(H, D, M) * ((H * D) ** -0.5)),
        }
    _A_in = _A_setup()

    def _B_setup():
        B, S, D, F = 4, 1, 512, 1792
        return {
            "x": _w((lambda *s: torch.randn(*s, dtype=torch.bfloat16) * 0.05)(B, S, D)),
            "w_gate": _w((lambda *s: torch.randn(*s, dtype=torch.bfloat16) * 0.05)(D, F)),
            "w_up": _w((lambda *s: torch.randn(*s, dtype=torch.bfloat16) * 0.05)(D, F)),
            "w_down": _w((lambda *s: torch.randn(*s, dtype=torch.bfloat16) * 0.05)(F, D)),
        }
    _B_in = _B_setup()

    return {
        "A_x": _A_in["x"],
        "A_c_kv": _A_in["c_kv"],
        "A_w_q": _A_in["w_q"],
        "A_w_uk": _A_in["w_uk"],
        "A_w_uv": _A_in["w_uv"],
        "A_w_o": _A_in["w_o"],
        "B_x": _B_in["x"],
        "B_w_gate": _B_in["w_gate"],
        "B_w_up": _B_in["w_up"],
        "B_w_down": _B_in["w_down"],
    }

def reference(A_x, A_c_kv, A_w_q, A_w_uk, A_w_uv, A_w_o, B_x, B_w_gate, B_w_up, B_w_down):
    def _A_ref(x, c_kv, w_q, w_uk, w_uv, w_o):
        B, Sq, M = x.shape[0], x.shape[1], x.shape[2]
        Sk = c_kv.shape[1]
        H, D = w_q.shape[1], w_q.shape[2]
        q = torch.einsum("bqm,mhd->bhqd", x, w_q)
        k = torch.einsum("bkc,chd->bhkd", c_kv, w_uk)
        v = torch.einsum("bkc,chd->bhkd", c_kv, w_uv)
        scores = torch.einsum("bhqd,bhkd->bhqk", q, k) * (D ** -0.5)
        off = Sk - Sq
        qi = torch.arange(Sq)[:, None]
        kj = torch.arange(Sk)[None, :]
        cmask = kj <= (qi + off)
        scores = torch.where(cmask[None, None], scores, -1e9)
        p = _softmax(scores, axis=-1)
        ctx = torch.einsum("bhqk,bhkd->bhqd", p, v)
        return torch.einsum("bhqd,hdm->bqm", ctx, w_o)

    def _B_ref(x, w_gate, w_up, w_down):
        return (_gelu(x @ w_gate) * (x @ w_up)) @ w_down

    x = A_x
    h = x + _A_ref(_layernorm(x, axis=-1), A_c_kv, A_w_q, A_w_uk, A_w_uv, A_w_o)
    h2 = h + _B_ref(_layernorm(h, axis=-1), B_w_gate, B_w_up, B_w_down)
    return h2
```

```asm
; @launch grid=(256,1,1) block=(512,1,1) lds=157392
.amdgcn_target "amdgcn-amd-amdhsa--gfx950"
.text
.globl sequential_preLN__compressed_kv_cla__geglu_ffn__decode_kernel
.p2align 8
.type sequential_preLN__compressed_kv_cla__geglu_ffn__decode_kernel,@function
sequential_preLN__compressed_kv_cla__geglu_ffn__decode_kernel:
L_code0:
    s_cmp_ge_u32 s2, 256
    s_cbranch_scc1 L_end
    s_load_dwordx16 s[48:63], s[0:1], 0
    s_load_dwordx8 s[64:71], s[0:1], 64
    s_load_dwordx2 s[72:73], s[0:1], 96
    v_lshrrev_b32 v4, 6, v0
    v_and_b32 v1, 63, v0
    v_readfirstlane_b32 s3, v4
    s_cmp_lg_u32 s3, 6
    s_cbranch_scc1 L_nopf
    s_getpc_b64 s[82:83]
L_pc:
    s_sub_u32 s82, s82, L_pc-L_code0
    s_subb_u32 s83, s83, 0
    s_lshr_b32 s84, s2, 3
    s_lshl_b32 s84, s84, 9
    v_lshlrev_b32 v4, 7, v1
    v_add_u32 v5, s84, v4
    s_mov_b32 exec_hi, 0
    v_mov_b32 v5, v4
    s_mov_b32 exec_hi, -1
    v_cmp_gt_u32 vcc, L_codeend-L_code0, v5
    s_mov_b32 exec_hi, 15
    s_and_b64 exec, exec, vcc
    global_load_dword v63, v5, s[82:83]
    s_mov_b64 exec, -1
L_nopf:
    v_and_b32 v2, 15, v0
    v_bfe_u32 v3, v0, 4, 2
    s_and_b32 s74, s2, 7
    s_lshr_b32 s82, s2, 6
    s_lshl_b32 s82, s82, 3
    s_or_b32 s74, s74, s82
    s_bfe_u32 s75, s2, 0x30003
    s_mov_b32 s6, 4096
    s_mov_b32 s7, 0x20000
    s_mov_b32 s10, 4194304
    s_mov_b32 s11, 0x20000
    s_cmp_lg_u32 s3, 4
    s_cbranch_scc1 L_not0
    s_setprio 3
    v_and_b32 v4, 3, v1
    v_lshlrev_b32 v4, 10, v4
    v_lshrrev_b32 v5, 2, v1
    v_lshl_add_u32 v5, v5, 4, v4
    v_lshl_add_u32 v4, v3, 4, v4
    v_lshlrev_b32 v6, 16, v3
    v_lshl_add_u32 v6, v2, 4, v6
    v_lshlrev_b32 v7, 13, v2
    v_lshl_add_u32 v7, v3, 4, v7
    s_lshl_b32 s84, s75, 7
    s_lshl_b32 s82, s75, 19
    s_lshl_b32 s83, s74, 8
    s_add_u32 s82, s82, s83
    s_waitcnt lgkmcnt(0)
    s_mov_b32 s4, s48
    s_mov_b32 s5, s49
    s_mov_b32 s8, s52
    s_mov_b32 s9, s53
    buffer_load_dwordx4 v[8:11], v5, s[4:7], 0 offen offset:0
    buffer_load_dwordx4 v[12:15], v5, s[4:7], 0 offen offset:256
    buffer_load_dwordx4 v[16:19], v5, s[4:7], 0 offen offset:512
    buffer_load_dwordx4 v[20:23], v5, s[4:7], 0 offen offset:768
    buffer_load_dwordx4 v[24:27], v4, s[4:7], s84 offen offset:0
    buffer_load_dwordx4 v[28:31], v4, s[4:7], s84 offen offset:64
    s_add_u32 s84, s82, 262144
    s_mov_b32 s83, s82
    buffer_load_dwordx4 v[64:67], v6, s[8:11], s83 offen
    s_addk_i32 s83, 0x2000
    buffer_load_dwordx4 v[68:71], v6, s[8:11], s83 offen
    s_addk_i32 s83, 0x2000
    buffer_load_dwordx4 v[72:75], v6, s[8:11], s83 offen
    s_addk_i32 s83, 0x2000
    buffer_load_dwordx4 v[76:79], v6, s[8:11], s83 offen
    s_addk_i32 s83, 0x2000
    buffer_load_dwordx4 v[80:83], v6, s[8:11], s83 offen
    s_addk_i32 s83, 0x2000
    buffer_load_dwordx4 v[84:87], v6, s[8:11], s83 offen
    s_addk_i32 s83, 0x2000
    buffer_load_dwordx4 v[88:91], v6, s[8:11], s83 offen
    s_addk_i32 s83, 0x2000
    buffer_load_dwordx4 v[92:95], v6, s[8:11], s83 offen
    buffer_load_dwordx4 v[96:99], v6, s[8:11], s84 offen
    s_addk_i32 s84, 0x2000
    buffer_load_dwordx4 v[100:103], v6, s[8:11], s84 offen
    s_addk_i32 s84, 0x2000
    buffer_load_dwordx4 v[104:107], v6, s[8:11], s84 offen
    s_addk_i32 s84, 0x2000
    buffer_load_dwordx4 v[108:111], v6, s[8:11], s84 offen
    s_addk_i32 s84, 0x2000
    buffer_load_dwordx4 v[112:115], v6, s[8:11], s84 offen
    s_addk_i32 s84, 0x2000
    buffer_load_dwordx4 v[116:119], v6, s[8:11], s84 offen
    s_addk_i32 s84, 0x2000
    buffer_load_dwordx4 v[120:123], v6, s[8:11], s84 offen
    s_addk_i32 s84, 0x2000
    buffer_load_dwordx4 v[124:127], v6, s[8:11], s84 offen
    s_mov_b32 s14, 4194304
    s_mov_b32 s15, 0x20000
    s_mov_b32 s18, 16777216
    s_mov_b32 s19, 0x20000
    s_mov_b32 s22, 268435456
    s_mov_b32 s23, 0x20000
    s_mov_b32 s26, 4194304
    s_mov_b32 s27, 0x20000
    s_mov_b32 s30, 4194304
    s_mov_b32 s31, 0x20000
    s_mov_b32 s34, 1835008
    s_mov_b32 s35, 0x20000
    s_mov_b32 s38, 1835008
    s_mov_b32 s39, 0x20000
    s_mov_b32 s42, 4096
    s_mov_b32 s43, 0x20000
    s_mov_b32 s46, 256
    s_mov_b32 s47, 0x20000
    s_mov_b32 s77, 0x05040100
    s_mov_b32 s78, 0x07060302
    s_mov_b32 s79, 0
    s_and_b32 s80, s75, 3
    s_lshr_b32 s81, s75, 2
    s_lshl1_add_u32 s81, s74, s81
    s_mov_b32 s12, s54
    s_mov_b32 s13, s55
    v_mov_b32 v187, v7
    s_mov_b32 s85, s82
    s_mov_b32 s16, s50
    s_mov_b32 s17, s51
    s_mov_b32 s20, s72
    s_mov_b32 s21, s73
    s_mov_b32 s24, s56
    s_mov_b32 s25, s57
    s_mov_b32 s28, s58
    s_mov_b32 s29, s59
    s_mov_b32 s36, s66
    s_mov_b32 s37, s67
    s_mov_b32 s40, s68
    s_mov_b32 s41, s69
    s_mov_b32 s44, s70
    s_mov_b32 s45, s71
    s_bitcmp1_b32 s3, 0
    s_cselect_b32 s32, s64, s62
    s_cselect_b32 s33, s65, s63
    s_load_dword s76, s[72:73], 0
    s_mov_b32 s48, 0xf000f
    s_mov_b32 s49, 0xf000f
    s_mov_b32 s50, 0xf000f0
    s_mov_b32 s51, 0xf000f0
    s_mov_b32 s52, 0xf000f00
    s_mov_b32 s53, 0xf000f00
    s_mov_b32 s54, 0xf000f000
    s_mov_b32 s55, 0xf000f000
    s_mov_b32 s56, 0x3f803f80
    v_mov_b32 v32, 0
    v_mov_b32 v33, 0
    s_waitcnt vmcnt(18)
    v_dot2_f32_bf16 v32, v8, s56, v32
    v_dot2_f32_bf16 v33, v8, v8, v33
    v_dot2_f32_bf16 v32, v9, s56, v32
    v_dot2_f32_bf16 v33, v9, v9, v33
    v_dot2_f32_bf16 v32, v10, s56, v32
    v_dot2_f32_bf16 v33, v10, v10, v33
    v_dot2_f32_bf16 v32, v11, s56, v32
    v_dot2_f32_bf16 v33, v11, v11, v33
    v_dot2_f32_bf16 v32, v12, s56, v32
    v_dot2_f32_bf16 v33, v12, v12, v33
    v_dot2_f32_bf16 v32, v13, s56, v32
    v_dot2_f32_bf16 v33, v13, v13, v33
    v_dot2_f32_bf16 v32, v14, s56, v32
    v_dot2_f32_bf16 v33, v14, v14, v33
    v_dot2_f32_bf16 v32, v15, s56, v32
    v_dot2_f32_bf16 v33, v15, v15, v33
    v_dot2_f32_bf16 v32, v16, s56, v32
    v_dot2_f32_bf16 v33, v16, v16, v33
    v_dot2_f32_bf16 v32, v17, s56, v32
    v_dot2_f32_bf16 v33, v17, v17, v33
    v_dot2_f32_bf16 v32, v18, s56, v32
    v_dot2_f32_bf16 v33, v18, v18, v33
    v_dot2_f32_bf16 v32, v19, s56, v32
    v_dot2_f32_bf16 v33, v19, v19, v33
    v_dot2_f32_bf16 v32, v20, s56, v32
    v_dot2_f32_bf16 v33, v20, v20, v33
    v_dot2_f32_bf16 v32, v21, s56, v32
    v_dot2_f32_bf16 v33, v21, v21, v33
    v_dot2_f32_bf16 v32, v22, s56, v32
    v_dot2_f32_bf16 v33, v22, v22, v33
    v_dot2_f32_bf16 v32, v23, s56, v32
    v_dot2_f32_bf16 v33, v23, v23, v33
    s_nop 1
    v_add_f32_dpp v32, v32, v32 row_ror:4 row_mask:0xf bank_mask:0xf
    v_add_f32_dpp v33, v33, v33 row_ror:4 row_mask:0xf bank_mask:0xf
    s_nop 0
    v_add_f32_dpp v32, v32, v32 row_ror:8 row_mask:0xf bank_mask:0xf
    v_add_f32_dpp v33, v33, v33 row_ror:8 row_mask:0xf bank_mask:0xf
    v_mov_b32 v34, v32
    v_mov_b32 v35, v33
    s_nop 0
    v_permlane16_swap_b32 v32, v34
    v_permlane16_swap_b32 v33, v35
    v_add_f32 v32, v32, v34
    v_add_f32 v33, v33, v35
    v_mov_b32 v34, v32
    v_mov_b32 v35, v33
    s_nop 0
    v_permlane32_swap_b32 v32, v34
    v_permlane32_swap_b32 v33, v35
    v_add_f32 v32, v32, v34
    v_add_f32 v33, v33, v35
    v_mul_f32 v32, 3137339392, v32
    v_mul_f32 v33, 989855744, v33
    v_fma_f32 v33, -v32, v32, v33
    v_max_f32 v33, 0, v33
    v_add_f32 v33, 925353388, v33
    v_rsq_f32 v33, v33
    s_nop 0
    v_mul_f32 v32, v32, v33
    s_waitcnt vmcnt(16)
    v_lshlrev_b32 v8, 16, v24
    v_and_b32 v9, 0xffff0000, v24
    v_lshlrev_b32 v10, 16, v25
    v_and_b32 v11, 0xffff0000, v25
    v_lshlrev_b32 v12, 16, v26
    v_and_b32 v13, 0xffff0000, v26
    v_lshlrev_b32 v14, 16, v27
    v_and_b32 v15, 0xffff0000, v27
    v_lshlrev_b32 v16, 16, v28
    v_and_b32 v17, 0xffff0000, v28
    v_lshlrev_b32 v18, 16, v29
    v_and_b32 v19, 0xffff0000, v29
    v_lshlrev_b32 v20, 16, v30
    v_and_b32 v21, 0xffff0000, v30
    v_lshlrev_b32 v22, 16, v31
    v_and_b32 v23, 0xffff0000, v31
    v_pk_fma_f32 v[8:9], v[8:9], v[32:33], v[32:33] op_sel:[0,1,0] op_sel_hi:[1,1,0]
    v_pk_fma_f32 v[10:11], v[10:11], v[32:33], v[32:33] op_sel:[0,1,0] op_sel_hi:[1,1,0]
    v_pk_fma_f32 v[12:13], v[12:13], v[32:33], v[32:33] op_sel:[0,1,0] op_sel_hi:[1,1,0]
    v_pk_fma_f32 v[14:15], v[14:15], v[32:33], v[32:33] op_sel:[0,1,0] op_sel_hi:[1,1,0]
    v_pk_fma_f32 v[16:17], v[16:17], v[32:33], v[32:33] op_sel:[0,1,0] op_sel_hi:[1,1,0]
    v_pk_fma_f32 v[18:19], v[18:19], v[32:33], v[32:33] op_sel:[0,1,0] op_sel_hi:[1,1,0]
    v_pk_fma_f32 v[20:21], v[20:21], v[32:33], v[32:33] op_sel:[0,1,0] op_sel_hi:[1,1,0]
    v_pk_fma_f32 v[22:23], v[22:23], v[32:33], v[32:33] op_sel:[0,1,0] op_sel_hi:[1,1,0]
    v_cvt_pk_bf16_f32 v24, v8, v9
    v_cvt_pk_bf16_f32 v25, v10, v11
    v_cvt_pk_bf16_f32 v26, v12, v13
    v_cvt_pk_bf16_f32 v27, v14, v15
    v_cvt_pk_bf16_f32 v28, v16, v17
    v_cvt_pk_bf16_f32 v29, v18, v19
    v_cvt_pk_bf16_f32 v30, v20, v21
    v_cvt_pk_bf16_f32 v31, v22, v23
    v_cndmask_b32 v32, 0, v24, s[48:49]
    v_cndmask_b32 v33, 0, v25, s[48:49]
    v_cndmask_b32 v34, 0, v26, s[48:49]
    v_cndmask_b32 v35, 0, v27, s[48:49]
    v_cndmask_b32 v36, 0, v28, s[48:49]
    v_cndmask_b32 v37, 0, v29, s[48:49]
    v_cndmask_b32 v38, 0, v30, s[48:49]
    v_cndmask_b32 v39, 0, v31, s[48:49]
    v_cndmask_b32 v40, 0, v24, s[50:51]
    v_cndmask_b32 v41, 0, v25, s[50:51]
    v_cndmask_b32 v42, 0, v26, s[50:51]
    v_cndmask_b32 v43, 0, v27, s[50:51]
    v_cndmask_b32 v44, 0, v28, s[50:51]
    v_cndmask_b32 v45, 0, v29, s[50:51]
    v_cndmask_b32 v46, 0, v30, s[50:51]
    v_cndmask_b32 v47, 0, v31, s[50:51]
    v_cndmask_b32 v48, 0, v24, s[52:53]
    v_cndmask_b32 v49, 0, v25, s[52:53]
    v_cndmask_b32 v50, 0, v26, s[52:53]
    v_cndmask_b32 v51, 0, v27, s[52:53]
    v_cndmask_b32 v52, 0, v28, s[52:53]
    v_cndmask_b32 v53, 0, v29, s[52:53]
    v_cndmask_b32 v54, 0, v30, s[52:53]
    v_cndmask_b32 v55, 0, v31, s[52:53]
    v_cndmask_b32 v56, 0, v24, s[54:55]
    v_cndmask_b32 v57, 0, v25, s[54:55]
    v_cndmask_b32 v58, 0, v26, s[54:55]
    v_cndmask_b32 v59, 0, v27, s[54:55]
    v_cndmask_b32 v60, 0, v28, s[54:55]
    v_cndmask_b32 v61, 0, v29, s[54:55]
    v_cndmask_b32 v62, 0, v30, s[54:55]
    v_cndmask_b32 v63, 0, v31, s[54:55]
    buffer_load_dwordx4 v[192:195], v187, s[12:15], s85 offen offset:0
    buffer_load_dwordx4 v[196:199], v187, s[12:15], s85 offen offset:64
    buffer_load_dwordx4 v[200:203], v187, s[12:15], s85 offen offset:128
    buffer_load_dwordx4 v[204:207], v187, s[12:15], s85 offen offset:192
    s_add_u32 s85, s85, 131072
    buffer_load_dwordx4 v[208:211], v187, s[12:15], s85 offen offset:0
    buffer_load_dwordx4 v[212:215], v187, s[12:15], s85 offen offset:64
    buffer_load_dwordx4 v[216:219], v187, s[12:15], s85 offen offset:128
    buffer_load_dwordx4 v[220:223], v187, s[12:15], s85 offen offset:192
    s_add_u32 s85, s85, 131072
    buffer_load_dwordx4 v[224:227], v187, s[12:15], s85 offen offset:0
    buffer_load_dwordx4 v[228:231], v187, s[12:15], s85 offen offset:64
    buffer_load_dwordx4 v[232:235], v187, s[12:15], s85 offen offset:128
    buffer_load_dwordx4 v[236:239], v187, s[12:15], s85 offen offset:192
    s_add_u32 s85, s85, 131072
    buffer_load_dwordx4 v[240:243], v187, s[12:15], s85 offen offset:0
    buffer_load_dwordx4 v[244:247], v187, s[12:15], s85 offen offset:64
    buffer_load_dwordx4 v[248:251], v187, s[12:15], s85 offen offset:128
    buffer_load_dwordx4 v[252:255], v187, s[12:15], s85 offen offset:192
    v_lshlrev_b32 v7, 4, v1
    s_lshl_b32 s57, s74, 14
    s_add_u32 s57, s57, 65536
    s_add_u32 s58, s57, 8192
    s_lshl_b32 s82, s75, 11
    s_add_u32 s82, s82, s57
    s_waitcnt lgkmcnt(0)
    s_mul_i32 s63, s76, 0x9E3779B1
    s_add_u32 s63, s63, 0x7F4A7C15
    s_and_b32 s76, s63, 0xBFFFBFFF
    v_mov_b32 v18, s76
    v_mov_b32 v19, s76
    v_mov_b32 v22, s76
    v_mov_b32 v23, s76
    s_waitcnt vmcnt(24)
    v_perm_b32 v128, v68, v64, s77
    v_perm_b32 v132, v68, v64, s78
    v_perm_b32 v129, v76, v72, s77
    v_perm_b32 v133, v76, v72, s78
    v_perm_b32 v130, v84, v80, s77
    v_perm_b32 v134, v84, v80, s78
    v_perm_b32 v131, v92, v88, s77
    v_perm_b32 v135, v92, v88, s78
    v_perm_b32 v136, v69, v65, s77
    v_perm_b32 v140, v69, v65, s78
    v_perm_b32 v137, v77, v73, s77
    v_perm_b32 v141, v77, v73, s78
    v_perm_b32 v138, v85, v81, s77
    v_perm_b32 v142, v85, v81, s78
    v_perm_b32 v139, v93, v89, s77
    v_perm_b32 v143, v93, v89, s78
    v_perm_b32 v144, v70, v66, s77
    v_perm_b32 v148, v70, v66, s78
    v_perm_b32 v145, v78, v74, s77
    v_perm_b32 v149, v78, v74, s78
    v_perm_b32 v146, v86, v82, s77
    v_perm_b32 v150, v86, v82, s78
    v_perm_b32 v147, v94, v90, s77
    v_perm_b32 v151, v94, v90, s78
    v_perm_b32 v152, v71, v67, s77
    v_perm_b32 v156, v71, v67, s78
    v_perm_b32 v153, v79, v75, s77
    v_perm_b32 v157, v79, v75, s78
    v_perm_b32 v154, v87, v83, s77
    v_perm_b32 v158, v87, v83, s78
    v_perm_b32 v155, v95, v91, s77
    v_perm_b32 v159, v95, v91, s78
    v_mfma_f32_16x16x32_bf16 v[8:11], v[32:35], v[128:131], 0
    v_mfma_f32_16x16x32_bf16 v[12:15], v[32:35], v[144:147], 0
    v_mfma_f32_16x16x32_bf16 v[8:11], v[40:43], v[132:135], v[8:11]
    v_mfma_f32_16x16x32_bf16 v[12:15], v[40:43], v[148:151], v[12:15]
    v_mfma_f32_16x16x32_bf16 v[8:11], v[48:51], v[136:139], v[8:11]
    v_mfma_f32_16x16x32_bf16 v[12:15], v[48:51], v[152:155], v[12:15]
    v_mfma_f32_16x16x32_bf16 v[8:11], v[56:59], v[140:143], v[8:11]
    v_mfma_f32_16x16x32_bf16 v[12:15], v[56:59], v[156:159], v[12:15]
    s_waitcnt vmcnt(16)
    v_perm_b32 v64, v100, v96, s77
    v_perm_b32 v68, v100, v96, s78
    v_perm_b32 v65, v108, v104, s77
    v_perm_b32 v69, v108, v104, s78
    v_perm_b32 v66, v116, v112, s77
    v_perm_b32 v70, v116, v112, s78
    v_perm_b32 v67, v124, v120, s77
    v_perm_b32 v71, v124, v120, s78
    v_perm_b32 v72, v101, v97, s77
    v_perm_b32 v76, v101, v97, s78
    v_perm_b32 v73, v109, v105, s77
    v_perm_b32 v77, v109, v105, s78
    v_perm_b32 v74, v117, v113, s77
    v_perm_b32 v78, v117, v113, s78
    v_perm_b32 v75, v125, v121, s77
    v_perm_b32 v79, v125, v121, s78
    v_perm_b32 v80, v102, v98, s77
    v_perm_b32 v84, v102, v98, s78
    v_perm_b32 v81, v110, v106, s77
    v_perm_b32 v85, v110, v106, s78
    v_perm_b32 v82, v118, v114, s77
    v_perm_b32 v86, v118, v114, s78
    v_perm_b32 v83, v126, v122, s77
    v_perm_b32 v87, v126, v122, s78
    v_perm_b32 v88, v103, v99, s77
    v_perm_b32 v92, v103, v99, s78
    v_perm_b32 v89, v111, v107, s77
    v_perm_b32 v93, v111, v107, s78
    v_perm_b32 v90, v119, v115, s77
    v_perm_b32 v94, v119, v115, s78
    v_perm_b32 v91, v127, v123, s77
    v_perm_b32 v95, v127, v123, s78
    v_mfma_f32_16x16x32_bf16 v[8:11], v[36:39], v[64:67], v[8:11]
    v_mfma_f32_16x16x32_bf16 v[12:15], v[36:39], v[80:83], v[12:15]
    v_mfma_f32_16x16x32_bf16 v[8:11], v[44:47], v[68:71], v[8:11]
    v_mfma_f32_16x16x32_bf16 v[12:15], v[44:47], v[84:87], v[12:15]
    v_mfma_f32_16x16x32_bf16 v[8:11], v[52:55], v[72:75], v[8:11]
    v_mfma_f32_16x16x32_bf16 v[12:15], v[52:55], v[88:91], v[12:15]
    v_mfma_f32_16x16x32_bf16 v[8:11], v[60:63], v[76:79], v[8:11]
    v_mfma_f32_16x16x32_bf16 v[12:15], v[60:63], v[92:95], v[12:15]
    s_nop 6
    v_cvt_pk_bf16_f32 v16, v8, v9
    v_cvt_pk_bf16_f32 v17, v10, v11
    buffer_store_dwordx4 v[16:19], v7, s[20:23], s82 offen offset:0 sc1
    v_cvt_pk_bf16_f32 v20, v12, v13
    v_cvt_pk_bf16_f32 v21, v14, v15
    buffer_store_dwordx4 v[20:23], v7, s[20:23], s82 offen offset:1024 sc1
    s_barrier
    v_and_b32 v4, 1, v2
    v_lshlrev_b32 v4, 4, v4
    v_mov_b32 v5, 0x3f80
    v_lshlrev_b32 v4, v4, v5
    v_and_b32 v5, 2, v2
    v_cmp_eq_u32 vcc, 0, v5
    s_nop 1
    v_cndmask_b32 v5, 0, v4, vcc
    v_cndmask_b32 v4, v4, 0, vcc
    v_cndmask_b32 v168, 0, v5, s[48:49]
    v_cndmask_b32 v169, 0, v4, s[48:49]
    v_mov_b32 v170, 0
    v_mov_b32 v171, 0
    v_cndmask_b32 v172, 0, v5, s[50:51]
    v_cndmask_b32 v173, 0, v4, s[50:51]
    v_mov_b32 v174, 0
    v_mov_b32 v175, 0
    v_cndmask_b32 v176, 0, v5, s[52:53]
    v_cndmask_b32 v177, 0, v4, s[52:53]
    v_mov_b32 v178, 0
    v_mov_b32 v179, 0
    v_cndmask_b32 v180, 0, v5, s[54:55]
    v_cndmask_b32 v181, 0, v4, s[54:55]
    v_mov_b32 v182, 0
    v_mov_b32 v183, 0
    v_lshrrev_b32 v4, 2, v2
    v_lshlrev_b32 v4, 1, v4
    v_lshrrev_b32 v5, 1, v3
    v_add_u32 v4, v4, v5
    s_lshl_b32 s82, s75, 3
    s_and_b32 s83, s74, 15
    s_xor_b32 s82, s82, s83
    v_xor_b32 v4, s82, v4
    v_lshlrev_b32 v4, 4, v4
    v_and_b32 v5, 1, v3
    v_lshl_add_u32 v4, v5, 3, v4
    v_and_b32 v5, 3, v2
    v_lshl_add_u32 v164, v5, 15, v4
    s_lshl_b32 s59, s74, 10
    s_add_u32 s59, s59, 1048576
    v_mov_b32 v186, 154176
    v_lshlrev_b32 v166, 11, v3
    v_lshl_add_u32 v166, v2, 4, v166
    v_lshlrev_b32 v167, 4, v2
    v_lshl_add_u32 v167, v3, 1, v167
    v_add_u32 v167, 153088, v167
    v_and_b32 v184, 3, v2
    v_mul_u32_u24 v184, 272, v184
    v_lshl_add_u32 v184, v3, 4, v184
    v_add_u32 v184, 153088, v184
    s_waitcnt vmcnt(0)
    buffer_load_dwordx4 v[64:67], v166, s[20:23], s57 offen offset:0 sc1
    buffer_load_dwordx4 v[68:71], v166, s[20:23], s57 offen offset:256 sc1
    buffer_load_dwordx4 v[72:75], v166, s[20:23], s57 offen offset:512 sc1
    buffer_load_dwordx4 v[76:79], v166, s[20:23], s57 offen offset:768 sc1
    buffer_load_dwordx4 v[80:83], v166, s[20:23], s57 offen offset:1024 sc1
    buffer_load_dwordx4 v[84:87], v166, s[20:23], s57 offen offset:1280 sc1
    buffer_load_dwordx4 v[88:91], v166, s[20:23], s57 offen offset:1536 sc1
    buffer_load_dwordx4 v[92:95], v166, s[20:23], s57 offen offset:1792 sc1
    buffer_load_dwordx4 v[96:99], v166, s[20:23], s58 offen offset:0 sc1
    buffer_load_dwordx4 v[100:103], v166, s[20:23], s58 offen offset:256 sc1
    buffer_load_dwordx4 v[104:107], v166, s[20:23], s58 offen offset:512 sc1
    buffer_load_dwordx4 v[108:111], v166, s[20:23], s58 offen offset:768 sc1
    buffer_load_dwordx4 v[112:115], v166, s[20:23], s58 offen offset:1024 sc1
    buffer_load_dwordx4 v[116:119], v166, s[20:23], s58 offen offset:1280 sc1
    buffer_load_dwordx4 v[120:123], v166, s[20:23], s58 offen offset:1536 sc1
    buffer_load_dwordx4 v[124:127], v166, s[20:23], s58 offen offset:1792 sc1
L_h1:
    s_waitcnt vmcnt(15)
    v_mfma_f32_16x16x32_bf16 v[8:11], v[168:171], v[64:67], 0
    v_xor_b32 v4, s76, v66
    s_waitcnt vmcnt(14)
    v_mfma_f32_16x16x32_bf16 v[8:11], v[172:175], v[68:71], v[8:11]
    v_bitop3_b32 v4, v70, s76, v4 bitop3:0xbe
    s_waitcnt vmcnt(13)
    v_mfma_f32_16x16x32_bf16 v[8:11], v[176:179], v[72:75], v[8:11]
    v_bitop3_b32 v4, v74, s76, v4 bitop3:0xbe
    s_waitcnt vmcnt(12)
    v_mfma_f32_16x16x32_bf16 v[8:11], v[180:183], v[76:79], v[8:11]
    v_bitop3_b32 v4, v78, s76, v4 bitop3:0xbe
    s_waitcnt vmcnt(11)
    v_mfma_f32_16x16x32_bf16 v[12:15], v[168:171], v[80:83], 0
    v_bitop3_b32 v4, v82, s76, v4 bitop3:0xbe
    s_waitcnt vmcnt(10)
    v_mfma_f32_16x16x32_bf16 v[12:15], v[172:175], v[84:87], v[12:15]
    v_bitop3_b32 v4, v86, s76, v4 bitop3:0xbe
    s_waitcnt vmcnt(9)
    v_mfma_f32_16x16x32_bf16 v[12:15], v[176:179], v[88:91], v[12:15]
    v_bitop3_b32 v4, v90, s76, v4 bitop3:0xbe
    s_waitcnt vmcnt(8)
    v_mfma_f32_16x16x32_bf16 v[12:15], v[180:183], v[92:95], v[12:15]
    v_bitop3_b32 v4, v94, s76, v4 bitop3:0xbe
    s_waitcnt vmcnt(7)
    v_mfma_f32_16x16x32_bf16 v[8:11], v[168:171], v[96:99], v[8:11]
    v_bitop3_b32 v4, v98, s76, v4 bitop3:0xbe
    s_waitcnt vmcnt(6)
    v_mfma_f32_16x16x32_bf16 v[8:11], v[172:175], v[100:103], v[8:11]
    v_bitop3_b32 v4, v102, s76, v4 bitop3:0xbe
    s_waitcnt vmcnt(5)
    v_mfma_f32_16x16x32_bf16 v[8:11], v[176:179], v[104:107], v[8:11]
    v_bitop3_b32 v4, v106, s76, v4 bitop3:0xbe
    s_waitcnt vmcnt(4)
    v_mfma_f32_16x16x32_bf16 v[8:11], v[180:183], v[108:111], v[8:11]
    v_bitop3_b32 v4, v110, s76, v4 bitop3:0xbe
    s_waitcnt vmcnt(3)
    v_mfma_f32_16x16x32_bf16 v[12:15], v[168:171], v[112:115], v[12:15]
    v_bitop3_b32 v4, v114, s76, v4 bitop3:0xbe
    s_waitcnt vmcnt(2)
    v_mfma_f32_16x16x32_bf16 v[12:15], v[172:175], v[116:119], v[12:15]
    v_bitop3_b32 v4, v118, s76, v4 bitop3:0xbe
    s_waitcnt vmcnt(1)
    v_mfma_f32_16x16x32_bf16 v[12:15], v[176:179], v[120:123], v[12:15]
    v_bitop3_b32 v4, v122, s76, v4 bitop3:0xbe
    s_waitcnt vmcnt(0)
    v_mfma_f32_16x16x32_bf16 v[12:15], v[180:183], v[124:127], v[12:15]
    v_bitop3_b32 v4, v126, s76, v4 bitop3:0xbe
    v_cmp_ne_u32 vcc, 0, v4
    s_cbranch_vccz L_h1ok
    s_sleep 2
    buffer_load_dwordx4 v[64:67], v166, s[20:23], s57 offen offset:0 sc1
    buffer_load_dwordx4 v[68:71], v166, s[20:23], s57 offen offset:256 sc1
    buffer_load_dwordx4 v[72:75], v166, s[20:23], s57 offen offset:512 sc1
    buffer_load_dwordx4 v[76:79], v166, s[20:23], s57 offen offset:768 sc1
    buffer_load_dwordx4 v[80:83], v166, s[20:23], s57 offen offset:1024 sc1
    buffer_load_dwordx4 v[84:87], v166, s[20:23], s57 offen offset:1280 sc1
    buffer_load_dwordx4 v[88:91], v166, s[20:23], s57 offen offset:1536 sc1
    buffer_load_dwordx4 v[92:95], v166, s[20:23], s57 offen offset:1792 sc1
    buffer_load_dwordx4 v[96:99], v166, s[20:23], s58 offen offset:0 sc1
    buffer_load_dwordx4 v[100:103], v166, s[20:23], s58 offen offset:256 sc1
    buffer_load_dwordx4 v[104:107], v166, s[20:23], s58 offen offset:512 sc1
    buffer_load_dwordx4 v[108:111], v166, s[20:23], s58 offen offset:768 sc1
    buffer_load_dwordx4 v[112:115], v166, s[20:23], s58 offen offset:1024 sc1
    buffer_load_dwordx4 v[116:119], v166, s[20:23], s58 offen offset:1280 sc1
    buffer_load_dwordx4 v[120:123], v166, s[20:23], s58 offen offset:1536 sc1
    buffer_load_dwordx4 v[124:127], v166, s[20:23], s58 offen offset:1792 sc1
    s_add_u32 s79, s79, 1
    s_cmp_lt_u32 s79, 200000
    s_cbranch_scc1 L_h1
    v_mov_b32 v4, 1
    v_mov_b32 v5, 0
    buffer_store_dword v4, v5, s[44:47], 0 offen offset:4
    s_waitcnt vmcnt(0)
L_h1ok:
    v_cvt_pk_bf16_f32 v16, v8, v9
    ds_write_b16 v167, v16 offset:0
    ds_write_b16_d16_hi v167, v16 offset:272
    v_cvt_pk_bf16_f32 v17, v10, v11
    ds_write_b16 v167, v17 offset:544
    ds_write_b16_d16_hi v167, v17 offset:816
    v_cvt_pk_bf16_f32 v18, v12, v13
    ds_write_b16 v167, v18 offset:8
    ds_write_b16_d16_hi v167, v18 offset:280
    v_cvt_pk_bf16_f32 v19, v14, v15
    ds_write_b16 v167, v19 offset:552
    ds_write_b16_d16_hi v167, v19 offset:824
    ds_read_b128 v[32:35], v184 offset:0
    ds_read_b128 v[36:39], v184 offset:64
    ds_read_b128 v[40:43], v184 offset:128
    ds_read_b128 v[44:47], v184 offset:192
    ds_read_b32 v10, v186
    s_mov_b32 s83, 4096
    s_waitcnt lgkmcnt(4)
    v_mfma_f32_16x16x32_bf16 v[48:51], v[192:195], v[32:35], 0
    v_mfma_f32_16x16x32_bf16 v[52:55], v[208:211], v[32:35], 0
    v_mfma_f32_16x16x32_bf16 v[56:59], v[224:227], v[32:35], 0
    v_mfma_f32_16x16x32_bf16 v[60:63], v[240:243], v[32:35], 0
    s_waitcnt lgkmcnt(3)
    v_mfma_f32_16x16x32_bf16 v[48:51], v[196:199], v[36:39], v[48:51]
    v_mfma_f32_16x16x32_bf16 v[52:55], v[212:215], v[36:39], v[52:55]
    v_mfma_f32_16x16x32_bf16 v[56:59], v[228:231], v[36:39], v[56:59]
    v_mfma_f32_16x16x32_bf16 v[60:63], v[244:247], v[36:39], v[60:63]
    s_waitcnt lgkmcnt(2)
    v_mfma_f32_16x16x32_bf16 v[48:51], v[200:203], v[40:43], v[48:51]
    v_mfma_f32_16x16x32_bf16 v[52:55], v[216:219], v[40:43], v[52:55]
    v_mfma_f32_16x16x32_bf16 v[56:59], v[232:235], v[40:43], v[56:59]
    v_mfma_f32_16x16x32_bf16 v[60:63], v[248:251], v[40:43], v[60:63]
    s_waitcnt lgkmcnt(1)
    v_mfma_f32_16x16x32_bf16 v[48:51], v[204:207], v[44:47], v[48:51]
    v_mfma_f32_16x16x32_bf16 v[52:55], v[220:223], v[44:47], v[52:55]
    v_mfma_f32_16x16x32_bf16 v[56:59], v[236:239], v[44:47], v[56:59]
    v_mfma_f32_16x16x32_bf16 v[60:63], v[252:255], v[44:47], v[60:63]
    s_mov_b64 exec, s[48:49]
    s_nop 3
    v_cvt_pk_bf16_f32 v8, v48, v49
    v_cvt_pk_bf16_f32 v9, v50, v51
    s_mov_b64 exec, s[50:51]
    v_cvt_pk_bf16_f32 v8, v52, v53
    v_cvt_pk_bf16_f32 v9, v54, v55
    s_mov_b64 exec, s[52:53]
    v_cvt_pk_bf16_f32 v8, v56, v57
    v_cvt_pk_bf16_f32 v9, v58, v59
    s_mov_b64 exec, s[54:55]
    v_cvt_pk_bf16_f32 v8, v60, v61
    v_cvt_pk_bf16_f32 v9, v62, v63
    s_mov_b64 exec, -1
L_sig:
    s_waitcnt lgkmcnt(0)
    v_cmp_ne_u32 vcc, s76, v10
    s_cbranch_vccz L_sigok
    ds_read_b32 v10, v186
    s_branch L_sig
L_sigok:
    buffer_store_dwordx2 v[8:9], v164, s[20:23], s59 offen sc1
    s_sleep 8
L_fl:
    buffer_load_dwordx4 v[12:15], v7, s[20:23], s83 offen sc1
    s_waitcnt vmcnt(0)
    v_xor_b32 v4, s76, v12
    v_bitop3_b32 v4, v13, s76, v4 bitop3:0xbe
    v_bitop3_b32 v4, v14, s76, v4 bitop3:0xbe
    v_bitop3_b32 v4, v15, s76, v4 bitop3:0xbe
    v_cmp_ne_u32 vcc, 0, v4
    s_cbranch_vccz L_flok
    s_sleep 2
    s_add_u32 s79, s79, 1
    s_cmp_lt_u32 s79, 200000
    s_cbranch_scc1 L_fl
    v_mov_b32 v4, 6
    v_mov_b32 v5, 0
    buffer_store_dword v4, v5, s[44:47], 0 offen offset:24
L_flok:
    s_branch L_pvp
L_not0:
    s_mov_b32 s14, 4194304
    s_mov_b32 s15, 0x20000
    s_mov_b32 s18, 16777216
    s_mov_b32 s19, 0x20000
    s_mov_b32 s22, 268435456
    s_mov_b32 s23, 0x20000
    s_mov_b32 s26, 4194304
    s_mov_b32 s27, 0x20000
    s_mov_b32 s30, 4194304
    s_mov_b32 s31, 0x20000
    s_mov_b32 s34, 1835008
    s_mov_b32 s35, 0x20000
    s_mov_b32 s38, 1835008
    s_mov_b32 s39, 0x20000
    s_mov_b32 s42, 4096
    s_mov_b32 s43, 0x20000
    s_mov_b32 s46, 256
    s_mov_b32 s47, 0x20000
    s_mov_b32 s77, 0x05040100
    s_mov_b32 s78, 0x07060302
    s_mov_b32 s79, 0
    s_and_b32 s80, s75, 3
    s_lshr_b32 s81, s75, 2
    s_lshl1_add_u32 s81, s74, s81
    v_lshlrev_b32 v7, 4, v1
    s_waitcnt lgkmcnt(0)
    s_mov_b32 s4, s48
    s_mov_b32 s5, s49
    s_mov_b32 s16, s50
    s_mov_b32 s17, s51
    s_mov_b32 s20, s72
    s_mov_b32 s21, s73
    s_mov_b32 s24, s56
    s_mov_b32 s25, s57
    s_mov_b32 s28, s58
    s_mov_b32 s29, s59
    s_mov_b32 s36, s66
    s_mov_b32 s37, s67
    s_mov_b32 s40, s68
    s_mov_b32 s41, s69
    s_mov_b32 s44, s70
    s_mov_b32 s45, s71
    s_bitcmp1_b32 s3, 0
    s_cselect_b32 s32, s64, s62
    s_cselect_b32 s33, s65, s63
    s_load_dword s76, s[72:73], 0
    s_cmp_lt_u32 s3, 4
    s_cbranch_scc1 L_s03
    s_cmp_lg_u32 s3, 5
    s_cbranch_scc1 L_not1
    s_setprio 3
    v_mov_b32 v8, -1
    v_mov_b32 v9, -1
    v_mov_b32 v10, -1
    v_mov_b32 v11, -1
    v_lshrrev_b32 v4, 2, v2
    v_lshlrev_b32 v4, 1, v4
    v_lshrrev_b32 v5, 1, v3
    v_add_u32 v4, v4, v5
    s_lshl_b32 s82, s75, 3
    s_and_b32 s83, s74, 15
    s_xor_b32 s82, s82, s83
    v_xor_b32 v4, s82, v4
    v_lshlrev_b32 v4, 4, v4
    v_and_b32 v5, 1, v3
    v_lshl_add_u32 v4, v5, 3, v4
    v_and_b32 v5, 3, v2
    v_lshl_add_u32 v12, v5, 15, v4
    s_lshl_b32 s59, s74, 10
    s_add_u32 s59, s59, 1048576
    buffer_store_dwordx2 v[8:9], v12, s[20:23], s59 offen sc1
    s_lshl_b32 s82, s80, 6
    s_add_u32 s82, s82, s81
    s_lshl_b32 s82, s82, 10
    s_add_u32 s83, s82, 7340032
    buffer_store_dwordx4 v[8:11], v7, s[20:23], s83 offen sc1
    s_add_u32 s83, s82, 7602176
    buffer_store_dwordx4 v[8:11], v7, s[20:23], s83 offen sc1
    s_waitcnt lgkmcnt(0)
    s_mul_i32 s63, s76, 0x9E3779B1
    s_add_u32 s63, s63, 0x7F4A7C15
    s_and_b32 s76, s63, 0xBFFFBFFF
    v_mov_b32 v14, s76
    v_mov_b32 v15, 0
    v_mov_b32 v16, 154176
    s_lshl_b32 s82, s2, 2
    s_add_u32 s82, s82, 4096
    s_waitcnt vmcnt(0)
    ds_write_b32 v16, v14
    s_mov_b64 exec, 1
    buffer_store_dword v14, v15, s[20:23], s82 offen sc1
    s_mov_b64 exec, -1
    s_waitcnt lgkmcnt(0)
    s_barrier
    s_branch L_not1b
L_not1:
    s_barrier
    s_waitcnt lgkmcnt(0)
    s_mul_i32 s63, s76, 0x9E3779B1
    s_add_u32 s63, s63, 0x7F4A7C15
    s_and_b32 s76, s63, 0xBFFFBFFF
L_not1b:
L_pvp:
    s_setprio 2
    s_and_b32 s56, s3, 3
    v_lshrrev_b32 v4, 2, v2
    v_lshlrev_b32 v4, 1, v4
    v_lshl_add_u32 v4, v3, 3, v4
    v_bfe_u32 v5, v2, 1, 1
    v_lshl_add_u32 v5, s56, 4, v5
    v_and_b32 v6, 15, v4
    v_xor_b32 v5, v5, v6
    v_lshlrev_b32 v5, 4, v5
    v_lshl_add_u32 v4, v4, 10, v5
    v_and_b32 v5, 1, v2
    v_lshl_add_u32 v4, v5, 3, v4
    v_xor_b32 v16, 0, v4
    v_xor_b32 v17, 1040, v4
    v_xor_b32 v18, 32, v4
    v_xor_b32 v19, 1072, v4
    v_xor_b32 v20, 64, v4
    v_xor_b32 v21, 1104, v4
    v_xor_b32 v22, 96, v4
    v_xor_b32 v23, 1136, v4
    v_xor_b32 v24, 128, v4
    v_xor_b32 v25, 1168, v4
    v_xor_b32 v26, 160, v4
    v_xor_b32 v27, 1200, v4
    v_xor_b32 v28, 192, v4
    v_xor_b32 v29, 1232, v4
    v_xor_b32 v30, 224, v4
    v_xor_b32 v31, 1264, v4
    v_lshlrev_b32 v8, 4, v2
    v_add_u32 v8, 147456, v8
    v_lshl_add_u32 v9, v3, 2, v8
    v_mul_u32_u24 v10, 80, v2
    v_lshl_add_u32 v10, v3, 4, v10
    v_add_u32 v10, 147712, v10
    v_and_b32 v4, 7, v2
    v_lshlrev_b32 v4, 17, v4
    v_lshl_add_u32 v4, v3, 4, v4
    v_lshrrev_b32 v5, 3, v2
    v_lshl_add_u32 v4, v5, 6, v4
    v_lshl_add_u32 v11, s56, 8, v4
    s_lshr_b32 s82, s2, 7
    s_lshl_b32 s84, s82, 21
    s_and_b32 s83, s2, 127
    s_lshl_b32 s85, s83, 10
    s_add_u32 s84, s84, s85
    s_add_u32 s48, s84, 2097152
    s_add_u32 s49, s48, 1048576
    s_lshl_b32 s83, s83, 1
    s_add_u32 s82, s82, s83
    s_lshl_b32 s82, s82, 2
    s_add_u32 s82, s82, s56
    s_lshl_b32 s82, s82, 8
    s_add_u32 s50, s82, 6291456
    s_mov_b32 s51, 0x800080
    s_bfe_u32 s82, s2, 0x20005
    s_lshl_b32 s82, s82, 15
    s_lshr_b32 s84, s2, 7
    s_lshl_b32 s84, s84, 14
    s_add_u32 s82, s82, s84
    s_lshl_b32 s84, s56, 12
    s_add_u32 s82, s82, s84
    s_add_u32 s58, s82, 1048576
    s_add_u32 s84, s84, 131072
    v_add_u32 v6, s84, v7
    s_mov_b32 s65, 0
    s_barrier
    buffer_load_dwordx4 v[192:195], v7, s[20:23], s58 offen offset:0 sc1
    buffer_load_dwordx4 v[196:199], v7, s[20:23], s58 offen offset:1024 sc1
    buffer_load_dwordx4 v[200:203], v7, s[20:23], s58 offen offset:2048 sc1
    buffer_load_dwordx4 v[204:207], v7, s[20:23], s58 offen offset:3072 sc1
L_qachk:
    s_waitcnt vmcnt(3)
    ds_write_b128 v6, v[192:195] offset:0
    v_max3_u32 v4, v192, v193, v194
    v_max_u32 v4, v4, v195
    s_waitcnt vmcnt(2)
    ds_write_b128 v6, v[196:199] offset:1024
    v_max3_u32 v4, v4, v196, v197
    v_max3_u32 v4, v4, v198, v199
    s_waitcnt vmcnt(1)
    ds_write_b128 v6, v[200:203] offset:2048
    v_max3_u32 v4, v4, v200, v201
    v_max3_u32 v4, v4, v202, v203
    s_waitcnt vmcnt(0)
    ds_write_b128 v6, v[204:207] offset:3072
    v_max3_u32 v4, v4, v204, v205
    v_max3_u32 v4, v4, v206, v207
    v_cmp_eq_u32 vcc, -1, v4
L_qaj:
    s_cbranch_vccz L_qaok
    s_add_u32 s65, s65, 1
    s_cmp_ge_u32 s65, 200000
    s_cbranch_scc1 L_qafail
    s_sleep 2
    s_waitcnt lgkmcnt(0)
    buffer_load_dwordx4 v[192:195], v7, s[20:23], s58 offen offset:0 sc1
    buffer_load_dwordx4 v[196:199], v7, s[20:23], s58 offen offset:1024 sc1
    buffer_load_dwordx4 v[200:203], v7, s[20:23], s58 offen offset:2048 sc1
    buffer_load_dwordx4 v[204:207], v7, s[20:23], s58 offen offset:3072 sc1
    s_branch L_qachk
L_qafail:
    v_mov_b32 v4, 2
    v_mov_b32 v5, 0
    buffer_store_dword v4, v5, s[44:47], 0 offen offset:8
L_qaok:
    s_waitcnt lgkmcnt(0)
    s_barrier
    s_cmp_lg_u32 s56, 0
    s_cbranch_scc1 L_pf_1_0
    s_lshl_b32 s82, s80, 20
    s_lshl_b32 s83, s81, 7
    s_add_u32 s82, s82, s83
    s_add_u32 s82, s82, 0
    v_lshlrev_b32 v5, 13, v1
    buffer_load_dword v0, v5, s[24:27], s82 offen
L_pf_1_0:
    s_cmp_lg_u32 s56, 1
    s_cbranch_scc1 L_pf_1_1
    s_lshl_b32 s82, s80, 20
    s_lshl_b32 s83, s81, 7
    s_add_u32 s82, s82, s83
    s_add_u32 s82, s82, 524288
    v_lshlrev_b32 v5, 13, v1
    buffer_load_dword v0, v5, s[24:27], s82 offen
L_pf_1_1:
    s_cmp_lg_u32 s56, 2
    s_cbranch_scc1 L_pf_1_2
    s_lshl_b32 s82, s81, 16
    s_lshl_b32 s83, s80, 14
    s_add_u32 s82, s82, s83
    s_add_u32 s82, s82, 0
    v_lshlrev_b32 v5, 7, v1
    buffer_load_dword v0, v5, s[28:31], s82 offen
L_pf_1_2:
    s_cmp_lg_u32 s56, 3
    s_cbranch_scc1 L_pf_1_3
    s_lshl_b32 s82, s81, 16
    s_lshl_b32 s83, s80, 14
    s_add_u32 s82, s82, s83
    s_add_u32 s82, s82, 8192
    v_lshlrev_b32 v5, 7, v1
    buffer_load_dword v0, v5, s[28:31], s82 offen
L_pf_1_3:
    s_setprio 0
    ds_read_b64_tr_b16 v[64:65], v16 offset:0
    ds_read_b64_tr_b16 v[66:67], v17 offset:0
    ds_read_b64_tr_b16 v[68:69], v18 offset:0
    ds_read_b64_tr_b16 v[70:71], v19 offset:0
    ds_read_b64_tr_b16 v[72:73], v20 offset:0
    ds_read_b64_tr_b16 v[74:75], v21 offset:0
    ds_read_b64_tr_b16 v[76:77], v22 offset:0
    ds_read_b64_tr_b16 v[78:79], v23 offset:0
    ds_read_b64_tr_b16 v[96:97], v16 offset:32768
    ds_read_b64_tr_b16 v[98:99], v17 offset:32768
    ds_read_b64_tr_b16 v[100:101], v18 offset:32768
    ds_read_b64_tr_b16 v[102:103], v19 offset:32768
    ds_read_b64_tr_b16 v[104:105], v20 offset:32768
    ds_read_b64_tr_b16 v[106:107], v21 offset:32768
    ds_read_b64_tr_b16 v[108:109], v22 offset:32768
    ds_read_b64_tr_b16 v[110:111], v23 offset:32768
    v_add_u32 v16, 0x10000, v16
    v_add_u32 v17, 0x10000, v17
    v_add_u32 v18, 0x10000, v18
    v_add_u32 v19, 0x10000, v19
    v_add_u32 v20, 0x10000, v20
    v_add_u32 v21, 0x10000, v21
    v_add_u32 v22, 0x10000, v22
    v_add_u32 v23, 0x10000, v23
    ds_read_b64_tr_b16 v[128:129], v16 offset:0
    ds_read_b64_tr_b16 v[130:131], v17 offset:0
    ds_read_b64_tr_b16 v[132:133], v18 offset:0
    ds_read_b64_tr_b16 v[134:135], v19 offset:0
    ds_read_b64_tr_b16 v[136:137], v20 offset:0
    ds_read_b64_tr_b16 v[138:139], v21 offset:0
    ds_read_b64_tr_b16 v[140:141], v22 offset:0
    ds_read_b64_tr_b16 v[142:143], v23 offset:0
    ds_read_b64_tr_b16 v[160:161], v16 offset:32768
    ds_read_b64_tr_b16 v[162:163], v17 offset:32768
    ds_read_b64_tr_b16 v[164:165], v18 offset:32768
    ds_read_b64_tr_b16 v[166:167], v19 offset:32768
    ds_read_b64_tr_b16 v[168:169], v20 offset:32768
    ds_read_b64_tr_b16 v[170:171], v21 offset:32768
    ds_read_b64_tr_b16 v[172:173], v22 offset:32768
    ds_read_b64_tr_b16 v[174:175], v23 offset:32768
    ds_read_b64_tr_b16 v[80:81], v24 offset:0
    ds_read_b64_tr_b16 v[82:83], v25 offset:0
    ds_read_b64_tr_b16 v[84:85], v26 offset:0
    ds_read_b64_tr_b16 v[86:87], v27 offset:0
    ds_read_b64_tr_b16 v[88:89], v28 offset:0
    ds_read_b64_tr_b16 v[90:91], v29 offset:0
    ds_read_b64_tr_b16 v[92:93], v30 offset:0
    ds_read_b64_tr_b16 v[94:95], v31 offset:0
    ds_read_b64_tr_b16 v[112:113], v24 offset:32768
    ds_read_b64_tr_b16 v[114:115], v25 offset:32768
    ds_read_b64_tr_b16 v[116:117], v26 offset:32768
    ds_read_b64_tr_b16 v[118:119], v27 offset:32768
    ds_read_b64_tr_b16 v[120:121], v28 offset:32768
    ds_read_b64_tr_b16 v[122:123], v29 offset:32768
    ds_read_b64_tr_b16 v[124:125], v30 offset:32768
    ds_read_b64_tr_b16 v[126:127], v31 offset:32768
    v_add_u32 v24, 0x10000, v24
    v_add_u32 v25, 0x10000, v25
    v_add_u32 v26, 0x10000, v26
    v_add_u32 v27, 0x10000, v27
    v_add_u32 v28, 0x10000, v28
    v_add_u32 v29, 0x10000, v29
    v_add_u32 v30, 0x10000, v30
    v_add_u32 v31, 0x10000, v31
    ds_read_b64_tr_b16 v[144:145], v24 offset:0
    ds_read_b64_tr_b16 v[146:147], v25 offset:0
    ds_read_b64_tr_b16 v[148:149], v26 offset:0
    ds_read_b64_tr_b16 v[150:151], v27 offset:0
    ds_read_b64_tr_b16 v[152:153], v28 offset:0
    ds_read_b64_tr_b16 v[154:155], v29 offset:0
    ds_read_b64_tr_b16 v[156:157], v30 offset:0
    ds_read_b64_tr_b16 v[158:159], v31 offset:0
    ds_read_b64_tr_b16 v[176:177], v24 offset:32768
    ds_read_b64_tr_b16 v[178:179], v25 offset:32768
    ds_read_b64_tr_b16 v[180:181], v26 offset:32768
    ds_read_b64_tr_b16 v[182:183], v27 offset:32768
    ds_read_b64_tr_b16 v[184:185], v28 offset:32768
    ds_read_b64_tr_b16 v[186:187], v29 offset:32768
    ds_read_b64_tr_b16 v[188:189], v30 offset:32768
    ds_read_b64_tr_b16 v[190:191], v31 offset:32768
    v_add_u32 v6, 148992, v7
    v_mov_b32 v15, s76
    s_setprio 1
    s_barrier
    ds_read_b128 v[48:51], v8
    ds_read_b128 v[16:19], v6 offset:0
    ds_read_b128 v[20:23], v6 offset:1024
    ds_read_b128 v[24:27], v6 offset:2048
    ds_read_b128 v[28:31], v6 offset:3072
    ds_read_b128 v[52:55], v10
    ds_read_b32 v56, v9
    s_waitcnt lgkmcnt(6)
    v_max3_i32 v12, v48, v49, v50
    v_max_i32 v12, v12, v51
    v_sub_u32 v4, v12, v48
    v_min_u32 v4, 255, v4
    v_mul_u32_u24 v4, s51, v4
    s_waitcnt lgkmcnt(5)
    v_pk_sub_u16 v16, v16, v4 clamp
    v_pk_sub_u16 v17, v17, v4 clamp
    v_pk_sub_u16 v18, v18, v4 clamp
    v_pk_sub_u16 v19, v19, v4 clamp
    s_nop 1
    v_mfma_f32_16x16x32_bf16 v[32:35], v[64:67], v[16:19], 0
    v_sub_u32 v4, v12, v49
    v_min_u32 v4, 255, v4
    v_mfma_f32_16x16x32_bf16 v[36:39], v[68:71], v[16:19], 0
    v_mul_u32_u24 v4, s51, v4
    s_waitcnt lgkmcnt(4)
    v_pk_sub_u16 v20, v20, v4 clamp
    v_mfma_f32_16x16x32_bf16 v[40:43], v[72:75], v[16:19], 0
    v_pk_sub_u16 v21, v21, v4 clamp
    v_pk_sub_u16 v22, v22, v4 clamp
    v_mfma_f32_16x16x32_bf16 v[44:47], v[76:79], v[16:19], 0
    v_pk_sub_u16 v23, v23, v4 clamp
    s_nop 1
    v_mfma_f32_16x16x32_bf16 v[32:35], v[96:99], v[20:23], v[32:35]
    v_sub_u32 v4, v12, v50
    v_min_u32 v4, 255, v4
    v_mfma_f32_16x16x32_bf16 v[36:39], v[100:103], v[20:23], v[36:39]
    v_mul_u32_u24 v4, s51, v4
    s_waitcnt lgkmcnt(3)
    v_pk_sub_u16 v24, v24, v4 clamp
    v_mfma_f32_16x16x32_bf16 v[40:43], v[104:107], v[20:23], v[40:43]
    v_pk_sub_u16 v25, v25, v4 clamp
    v_pk_sub_u16 v26, v26, v4 clamp
    v_mfma_f32_16x16x32_bf16 v[44:47], v[108:111], v[20:23], v[44:47]
    v_pk_sub_u16 v27, v27, v4 clamp
    s_nop 1
    v_mfma_f32_16x16x32_bf16 v[32:35], v[128:131], v[24:27], v[32:35]
    v_sub_u32 v4, v12, v51
    v_min_u32 v4, 255, v4
    v_mfma_f32_16x16x32_bf16 v[36:39], v[132:135], v[24:27], v[36:39]
    v_mul_u32_u24 v4, s51, v4
    s_waitcnt lgkmcnt(2)
    v_pk_sub_u16 v28, v28, v4 clamp
    v_mfma_f32_16x16x32_bf16 v[40:43], v[136:139], v[24:27], v[40:43]
    v_pk_sub_u16 v29, v29, v4 clamp
    v_pk_sub_u16 v30, v30, v4 clamp
    v_mfma_f32_16x16x32_bf16 v[44:47], v[140:143], v[24:27], v[44:47]
    v_pk_sub_u16 v31, v31, v4 clamp
    s_nop 1
    v_mfma_f32_16x16x32_bf16 v[32:35], v[160:163], v[28:31], v[32:35]
    s_waitcnt lgkmcnt(0)
    v_pk_add_f32 v[52:53], v[52:53], v[54:55]
    v_sub_u32 v5, v56, v12
    v_mfma_f32_16x16x32_bf16 v[36:39], v[164:167], v[28:31], v[36:39]
    v_cvt_f32_i32 v12, v12
    v_add_f32 v13, v52, v53
    v_mfma_f32_16x16x32_bf16 v[40:43], v[168:171], v[28:31], v[40:43]
    v_ldexp_f32 v13, v13, v5
    v_mfma_f32_16x16x32_bf16 v[44:47], v[172:175], v[28:31], v[44:47]
    v_mfma_f32_16x16x32_bf16 v[48:51], v[80:83], v[16:19], 0
    v_mov_b32 v5, v13
    s_nop 1
    v_permlane16_swap_b32 v13, v5
    v_mfma_f32_16x16x32_bf16 v[52:55], v[84:87], v[16:19], 0
    v_add_f32 v13, v13, v5
    v_mov_b32 v14, v13
    v_mfma_f32_16x16x32_bf16 v[56:59], v[88:91], v[16:19], 0
    s_nop 0
    v_permlane32_swap_b32 v13, v14
    v_add_f32 v13, v13, v14
    v_mfma_f32_16x16x32_bf16 v[60:63], v[92:95], v[16:19], 0
    v_cvt_pk_bf16_f32 v64, v32, v33
    v_cvt_pk_bf16_f32 v65, v34, v35
    v_mfma_f32_16x16x32_bf16 v[48:51], v[112:115], v[20:23], v[48:51]
    v_cvt_pk_bf16_f32 v66, v36, v37
    v_cvt_pk_bf16_f32 v67, v38, v39
    v_mfma_f32_16x16x32_bf16 v[52:55], v[116:119], v[20:23], v[52:55]
    v_cvt_pk_bf16_f32 v68, v40, v41
    v_cvt_pk_bf16_f32 v69, v42, v43
    v_mfma_f32_16x16x32_bf16 v[56:59], v[120:123], v[20:23], v[56:59]
    v_cvt_pk_bf16_f32 v70, v44, v45
    v_cvt_pk_bf16_f32 v71, v46, v47
    v_mfma_f32_16x16x32_bf16 v[60:63], v[124:127], v[20:23], v[60:63]
    v_mov_b32 v80, v64
    v_mov_b32 v81, v65
    v_mfma_f32_16x16x32_bf16 v[48:51], v[144:147], v[24:27], v[48:51]
    v_mov_b32 v82, v66
    v_mov_b32 v83, v67
    v_mfma_f32_16x16x32_bf16 v[52:55], v[148:151], v[24:27], v[52:55]
    v_mov_b32_dpp v64, v68 row_ror:8 row_mask:0xf bank_mask:0xc
    v_mov_b32_dpp v65, v69 row_ror:8 row_mask:0xf bank_mask:0xc
    v_mfma_f32_16x16x32_bf16 v[56:59], v[152:155], v[24:27], v[56:59]
    v_mov_b32_dpp v66, v70 row_ror:8 row_mask:0xf bank_mask:0xc
    v_mov_b32_dpp v67, v71 row_ror:8 row_mask:0xf bank_mask:0xc
    v_mfma_f32_16x16x32_bf16 v[60:63], v[156:159], v[24:27], v[60:63]
    buffer_store_dwordx4 v[64:67], v11, s[20:23], s48 offen offset:0 sc1
    v_mov_b32_dpp v68, v80 row_ror:8 row_mask:0xf bank_mask:0x3
    v_mfma_f32_16x16x32_bf16 v[48:51], v[176:179], v[28:31], v[48:51]
    v_mov_b32_dpp v69, v81 row_ror:8 row_mask:0xf bank_mask:0x3
    v_mov_b32_dpp v70, v82 row_ror:8 row_mask:0xf bank_mask:0x3
    v_mfma_f32_16x16x32_bf16 v[52:55], v[180:183], v[28:31], v[52:55]
    v_mov_b32_dpp v71, v83 row_ror:8 row_mask:0xf bank_mask:0x3
    buffer_store_dwordx4 v[68:71], v11, s[20:23], s49 offen offset:0 sc1
    v_mfma_f32_16x16x32_bf16 v[56:59], v[184:187], v[28:31], v[56:59]
    v_mfma_f32_16x16x32_bf16 v[60:63], v[188:191], v[28:31], v[60:63]
    s_nop 0
    v_cvt_pk_bf16_f32 v72, v48, v49
    v_cvt_pk_bf16_f32 v73, v50, v51
    s_nop 0
    v_cvt_pk_bf16_f32 v74, v52, v53
    v_cvt_pk_bf16_f32 v75, v54, v55
    s_nop 0
    v_cvt_pk_bf16_f32 v76, v56, v57
    v_cvt_pk_bf16_f32 v77, v58, v59
    v_cvt_pk_bf16_f32 v78, v60, v61
    v_cvt_pk_bf16_f32 v79, v62, v63
    v_mov_b32 v80, v72
    v_mov_b32 v81, v73
    v_mov_b32 v82, v74
    v_mov_b32 v83, v75
    v_mov_b32_dpp v72, v76 row_ror:8 row_mask:0xf bank_mask:0xc
    v_mov_b32_dpp v73, v77 row_ror:8 row_mask:0xf bank_mask:0xc
    v_mov_b32_dpp v74, v78 row_ror:8 row_mask:0xf bank_mask:0xc
    v_mov_b32_dpp v75, v79 row_ror:8 row_mask:0xf bank_mask:0xc
    buffer_store_dwordx4 v[72:75], v11, s[20:23], s48 offen offset:128 sc1
    v_mov_b32_dpp v76, v80 row_ror:8 row_mask:0xf bank_mask:0x3
    v_mov_b32_dpp v77, v81 row_ror:8 row_mask:0xf bank_mask:0x3
    v_mov_b32_dpp v78, v82 row_ror:8 row_mask:0xf bank_mask:0x3
    v_mov_b32_dpp v79, v83 row_ror:8 row_mask:0xf bank_mask:0x3
    buffer_store_dwordx4 v[76:79], v11, s[20:23], s49 offen offset:128 sc1
    s_barrier
    v_bitop3_b32 v4, v64, v65, v66 bitop3:0x96
    v_bitop3_b32 v5, v68, v69, v70 bitop3:0x96
    v_bitop3_b32 v4, v4, v67, v72 bitop3:0x96
    v_bitop3_b32 v5, v5, v71, v76 bitop3:0x96
    v_bitop3_b32 v4, v4, v73, v74 bitop3:0x96
    v_bitop3_b32 v5, v5, v77, v78 bitop3:0x96
    v_xor_b32 v4, v4, v75
    v_xor_b32 v5, v5, v79
    s_nop 0
    v_xor_b32_dpp v14, v4, v4 row_ror:8 row_mask:0xf bank_mask:0xf
    s_nop 1
    v_xor_b32_dpp v14, v5, v5 row_ror:8 row_mask:0xf bank_mask:0xc
    v_mov_b32 v5, v14
    s_nop 1
    v_permlane16_swap_b32 v14, v5
    v_xor_b32 v14, v14, v5
    v_mov_b32 v5, v14
    s_nop 1
    v_permlane32_swap_b32 v14, v5
    v_xor_b32 v14, v14, v5
    v_bitop3_b32 v14, v14, v12, v13 bitop3:0x96
    s_mov_b64 exec, 0xffff
    buffer_store_dwordx4 v[12:15], v7, s[20:23], s50 offen sc1
    s_mov_b64 exec, -1
    s_branch L_p45b
L_s03:
    v_xor_b32 v8, 0, v7
    v_xor_b32 v9, 16, v7
    v_xor_b32 v10, 32, v7
    v_xor_b32 v11, 48, v7
    v_xor_b32 v12, 64, v7
    v_xor_b32 v13, 80, v7
    v_xor_b32 v14, 96, v7
    v_xor_b32 v15, 112, v7
    v_xor_b32 v16, 128, v7
    v_xor_b32 v17, 144, v7
    v_xor_b32 v18, 160, v7
    v_xor_b32 v19, 176, v7
    v_xor_b32 v20, 192, v7
    v_xor_b32 v21, 208, v7
    v_xor_b32 v22, 224, v7
    v_xor_b32 v23, 240, v7
    s_lshl_b32 s83, s3, 15
    s_and_b32 s82, s2, 127
    s_lshl_b32 s82, s82, 17
    s_lshl_b32 s85, s3, 15
    s_add_u32 s82, s82, s85
    s_barrier
    s_add_u32 m0, s83, 0
    s_add_u32 s84, s82, 0
    buffer_load_dwordx4 v8, s[16:19], s84 offen offset:0 lds
    buffer_load_dwordx4 v9, s[16:19], s84 offen offset:1024 lds
    buffer_load_dwordx4 v10, s[16:19], s84 offen offset:2048 lds
    buffer_load_dwordx4 v11, s[16:19], s84 offen offset:3072 lds
    s_add_u32 m0, s83, 4096
    s_add_u32 s84, s82, 4096
    buffer_load_dwordx4 v12, s[16:19], s84 offen offset:0 lds
    s_waitcnt vmcnt(4)
    buffer_load_dwordx4 v13, s[16:19], s84 offen offset:1024 lds
    s_waitcnt vmcnt(4)
    buffer_load_dwordx4 v14, s[16:19], s84 offen offset:2048 lds
    s_waitcnt vmcnt(4)
    buffer_load_dwordx4 v15, s[16:19], s84 offen offset:3072 lds
    s_add_u32 m0, s83, 8192
    s_add_u32 s84, s82, 8192
    buffer_load_dwordx4 v16, s[16:19], s84 offen offset:0 lds
    buffer_load_dwordx4 v17, s[16:19], s84 offen offset:1024 lds
    s_waitcnt vmcnt(9)
    buffer_load_dwordx4 v18, s[16:19], s84 offen offset:2048 lds
    s_waitcnt vmcnt(9)
    buffer_load_dwordx4 v19, s[16:19], s84 offen offset:3072 lds
    s_add_u32 m0, s83, 12288
    s_add_u32 s84, s82, 12288
    s_waitcnt vmcnt(9)
    buffer_load_dwordx4 v20, s[16:19], s84 offen offset:0 lds
    s_waitcnt vmcnt(9)
    buffer_load_dwordx4 v21, s[16:19], s84 offen offset:1024 lds
    s_waitcnt vmcnt(9)
    buffer_load_dwordx4 v22, s[16:19], s84 offen offset:2048 lds
    s_waitcnt vmcnt(9)
    buffer_load_dwordx4 v23, s[16:19], s84 offen offset:3072 lds
    s_add_u32 m0, s83, 16384
    s_add_u32 s84, s82, 16384
    s_waitcnt vmcnt(9)
    buffer_load_dwordx4 v8, s[16:19], s84 offen offset:0 lds
    s_waitcnt vmcnt(9)
    buffer_load_dwordx4 v9, s[16:19], s84 offen offset:1024 lds
    s_waitcnt vmcnt(9)
    buffer_load_dwordx4 v10, s[16:19], s84 offen offset:2048 lds
    s_waitcnt vmcnt(9)
    buffer_load_dwordx4 v11, s[16:19], s84 offen offset:3072 lds
    s_add_u32 m0, s83, 20480
    s_add_u32 s84, s82, 20480
    s_waitcnt vmcnt(9)
    buffer_load_dwordx4 v12, s[16:19], s84 offen offset:0 lds
    s_waitcnt vmcnt(9)
    buffer_load_dwordx4 v13, s[16:19], s84 offen offset:1024 lds
    s_waitcnt vmcnt(9)
    buffer_load_dwordx4 v14, s[16:19], s84 offen offset:2048 lds
    s_waitcnt vmcnt(9)
    buffer_load_dwordx4 v15, s[16:19], s84 offen offset:3072 lds
    s_add_u32 m0, s83, 24576
    s_add_u32 s84, s82, 24576
    s_waitcnt vmcnt(9)
    buffer_load_dwordx4 v16, s[16:19], s84 offen offset:0 lds
    s_waitcnt vmcnt(9)
    buffer_load_dwordx4 v17, s[16:19], s84 offen offset:1024 lds
    s_waitcnt vmcnt(9)
    buffer_load_dwordx4 v18, s[16:19], s84 offen offset:2048 lds
    s_waitcnt vmcnt(9)
    buffer_load_dwordx4 v19, s[16:19], s84 offen offset:3072 lds
    s_add_u32 m0, s83, 28672
    s_add_u32 s84, s82, 28672
    s_waitcnt vmcnt(9)
    buffer_load_dwordx4 v20, s[16:19], s84 offen offset:0 lds
    s_waitcnt vmcnt(9)
    buffer_load_dwordx4 v21, s[16:19], s84 offen offset:1024 lds
    s_waitcnt vmcnt(9)
    buffer_load_dwordx4 v22, s[16:19], s84 offen offset:2048 lds
    s_waitcnt vmcnt(9)
    buffer_load_dwordx4 v23, s[16:19], s84 offen offset:3072 lds
    s_waitcnt vmcnt(6)
    s_barrier
    s_waitcnt lgkmcnt(0)
    s_mul_i32 s63, s76, 0x9E3779B1
    s_add_u32 s63, s63, 0x7F4A7C15
    s_and_b32 s76, s63, 0xBFFFBFFF
    v_add_u32 v4, 0, v3
    v_xor_b32 v4, v4, v2
    v_lshlrev_b32 v4, 4, v4
    v_lshl_add_u32 v4, v2, 10, v4
    v_add_u32 v20, 131072, v4
    v_lshl_add_u32 v16, s3, 15, v4
    v_add_u32 v4, 4, v3
    v_xor_b32 v4, v4, v2
    v_lshlrev_b32 v4, 4, v4
    v_lshl_add_u32 v4, v2, 10, v4
    v_add_u32 v21, 131072, v4
    v_lshl_add_u32 v17, s3, 15, v4
    v_add_u32 v4, 8, v3
    v_xor_b32 v4, v4, v2
    v_lshlrev_b32 v4, 4, v4
    v_lshl_add_u32 v4, v2, 10, v4
    v_add_u32 v22, 131072, v4
    v_lshl_add_u32 v18, s3, 15, v4
    v_add_u32 v4, 12, v3
    v_xor_b32 v4, v4, v2
    v_lshlrev_b32 v4, 4, v4
    v_lshl_add_u32 v4, v2, 10, v4
    v_add_u32 v23, 131072, v4
    v_lshl_add_u32 v19, s3, 15, v4
    v_lshlrev_b32 v24, 4, v2
    v_lshl_add_u32 v24, s3, 2, v24
    v_add_u32 v24, 147456, v24
    s_lshl_b32 s82, s3, 10
    s_add_u32 s82, s82, 148992
    v_lshrrev_b32 v4, 1, v3
    v_lshlrev_b32 v4, 8, v4
    v_lshl_add_u32 v4, v2, 4, v4
    v_and_b32 v5, 1, v3
    v_lshl_add_u32 v4, v5, 2, v4
    v_add_u32 v25, s82, v4
    v_mul_u32_u24 v4, 80, v2
    v_lshl_add_u32 v4, v3, 2, v4
    v_lshl_add_u32 v4, s3, 4, v4
    v_add_u32 v26, 147712, v4
    s_mov_b32 s62, 1040356334
    s_waitcnt vmcnt(0)
    ds_read_b128 v[64:67], v16 offset:0
    ds_read_b128 v[68:71], v16 offset:16384
    ds_read_b128 v[72:75], v17 offset:0
    ds_read_b128 v[76:79], v17 offset:16384
    ds_read_b128 v[80:83], v18 offset:0
    ds_read_b128 v[84:87], v18 offset:16384
    ds_read_b128 v[88:91], v19 offset:0
    ds_read_b128 v[92:95], v19 offset:16384
    ds_read_b128 v[96:99], v16 offset:256
    ds_read_b128 v[100:103], v16 offset:16640
    ds_read_b128 v[104:107], v17 offset:256
    ds_read_b128 v[108:111], v17 offset:16640
    ds_read_b128 v[112:115], v18 offset:256
    ds_read_b128 v[116:119], v18 offset:16640
    ds_read_b128 v[120:123], v19 offset:256
    ds_read_b128 v[124:127], v19 offset:16640
    ds_read_b128 v[128:131], v16 offset:512
    ds_read_b128 v[132:135], v16 offset:16896
    ds_read_b128 v[136:139], v17 offset:512
    ds_read_b128 v[140:143], v17 offset:16896
    ds_read_b128 v[144:147], v18 offset:512
    ds_read_b128 v[148:151], v18 offset:16896
    ds_read_b128 v[152:155], v19 offset:512
    ds_read_b128 v[156:159], v19 offset:16896
    ds_read_b128 v[160:163], v16 offset:768
    ds_read_b128 v[164:167], v16 offset:17152
    ds_read_b128 v[168:171], v17 offset:768
    ds_read_b128 v[172:175], v17 offset:17152
    ds_read_b128 v[176:179], v18 offset:768
    ds_read_b128 v[180:183], v18 offset:17152
    ds_read_b128 v[184:187], v19 offset:768
    ds_read_b128 v[188:191], v19 offset:17152
    s_barrier
    s_setprio 2
    ds_read_b128 v[192:195], v20 offset:0
    ds_read_b128 v[196:199], v21 offset:0
    ds_read_b128 v[200:203], v22 offset:0
    ds_read_b128 v[204:207], v23 offset:0
    ds_read_b128 v[208:211], v20 offset:256
    ds_read_b128 v[212:215], v21 offset:256
    ds_read_b128 v[216:219], v22 offset:256
    ds_read_b128 v[220:223], v23 offset:256
    ds_read_b128 v[224:227], v20 offset:512
    ds_read_b128 v[228:231], v21 offset:512
    ds_read_b128 v[232:235], v22 offset:512
    ds_read_b128 v[236:239], v23 offset:512
    ds_read_b128 v[240:243], v20 offset:768
    ds_read_b128 v[244:247], v21 offset:768
    ds_read_b128 v[248:251], v22 offset:768
    ds_read_b128 v[252:255], v23 offset:768
    s_waitcnt lgkmcnt(15)
    v_mfma_f32_16x16x32_bf16 v[8:11], v[64:67], v[192:195], 0
    v_mfma_f32_16x16x32_bf16 v[12:15], v[68:71], v[192:195], 0
    s_waitcnt lgkmcnt(14)
    v_mfma_f32_16x16x32_bf16 v[8:11], v[72:75], v[196:199], v[8:11]
    v_mfma_f32_16x16x32_bf16 v[12:15], v[76:79], v[196:199], v[12:15]
    s_waitcnt lgkmcnt(13)
    v_mfma_f32_16x16x32_bf16 v[8:11], v[80:83], v[200:203], v[8:11]
    v_mfma_f32_16x16x32_bf16 v[12:15], v[84:87], v[200:203], v[12:15]
    s_waitcnt lgkmcnt(12)
    v_mfma_f32_16x16x32_bf16 v[8:11], v[88:91], v[204:207], v[8:11]
    v_mfma_f32_16x16x32_bf16 v[12:15], v[92:95], v[204:207], v[12:15]
    s_waitcnt lgkmcnt(11)
    v_mfma_f32_16x16x32_bf16 v[8:11], v[96:99], v[208:211], v[8:11]
    v_mfma_f32_16x16x32_bf16 v[12:15], v[100:103], v[208:211], v[12:15]
    s_waitcnt lgkmcnt(10)
    v_mfma_f32_16x16x32_bf16 v[8:11], v[104:107], v[212:215], v[8:11]
    v_mfma_f32_16x16x32_bf16 v[12:15], v[108:111], v[212:215], v[12:15]
    s_waitcnt lgkmcnt(9)
    v_mfma_f32_16x16x32_bf16 v[8:11], v[112:115], v[216:219], v[8:11]
    v_mfma_f32_16x16x32_bf16 v[12:15], v[116:119], v[216:219], v[12:15]
    s_waitcnt lgkmcnt(8)
    v_mfma_f32_16x16x32_bf16 v[8:11], v[120:123], v[220:223], v[8:11]
    v_mfma_f32_16x16x32_bf16 v[12:15], v[124:127], v[220:223], v[12:15]
    s_waitcnt lgkmcnt(7)
    v_mfma_f32_16x16x32_bf16 v[8:11], v[128:131], v[224:227], v[8:11]
    v_mfma_f32_16x16x32_bf16 v[12:15], v[132:135], v[224:227], v[12:15]
    s_waitcnt lgkmcnt(6)
    v_mfma_f32_16x16x32_bf16 v[8:11], v[136:139], v[228:231], v[8:11]
    v_mfma_f32_16x16x32_bf16 v[12:15], v[140:143], v[228:231], v[12:15]
    s_waitcnt lgkmcnt(5)
    v_mfma_f32_16x16x32_bf16 v[8:11], v[144:147], v[232:235], v[8:11]
    v_mfma_f32_16x16x32_bf16 v[12:15], v[148:151], v[232:235], v[12:15]
    s_waitcnt lgkmcnt(4)
    v_mfma_f32_16x16x32_bf16 v[8:11], v[152:155], v[236:239], v[8:11]
    v_mfma_f32_16x16x32_bf16 v[12:15], v[156:159], v[236:239], v[12:15]
    s_waitcnt lgkmcnt(3)
    v_mfma_f32_16x16x32_bf16 v[8:11], v[160:163], v[240:243], v[8:11]
    v_mfma_f32_16x16x32_bf16 v[12:15], v[164:167], v[240:243], v[12:15]
    s_waitcnt lgkmcnt(2)
    v_mfma_f32_16x16x32_bf16 v[8:11], v[168:171], v[244:247], v[8:11]
    v_mfma_f32_16x16x32_bf16 v[12:15], v[172:175], v[244:247], v[12:15]
    s_waitcnt lgkmcnt(1)
    v_mfma_f32_16x16x32_bf16 v[8:11], v[176:179], v[248:251], v[8:11]
    v_mfma_f32_16x16x32_bf16 v[12:15], v[180:183], v[248:251], v[12:15]
    s_waitcnt lgkmcnt(0)
    v_mfma_f32_16x16x32_bf16 v[8:11], v[184:187], v[252:255], v[8:11]
    v_mfma_f32_16x16x32_bf16 v[12:15], v[188:191], v[252:255], v[12:15]
    s_nop 6
    v_max3_f32 v28, v8, v9, v10
    v_max3_f32 v29, v11, v12, v13
    v_max3_f32 v28, v28, v14, v15
    v_max_f32 v28, v28, v29
    v_mov_b32 v29, v28
    s_nop 1
    v_permlane16_swap_b32 v28, v29
    v_max_f32 v28, v28, v29
    v_mov_b32 v29, v28
    s_nop 1
    v_permlane32_swap_b32 v28, v29
    v_max_f32 v28, v28, v29
    v_mul_f32 v28, s62, v28
    v_ceil_f32 v28, v28
    v_fma_f32 v8, v8, s62, -v28
    v_fma_f32 v9, v9, s62, -v28
    v_fma_f32 v10, v10, s62, -v28
    v_fma_f32 v11, v11, s62, -v28
    v_fma_f32 v12, v12, s62, -v28
    v_fma_f32 v13, v13, s62, -v28
    v_fma_f32 v14, v14, s62, -v28
    v_fma_f32 v15, v15, s62, -v28
    v_cvt_i32_f32 v28, v28
    v_exp_f32 v8, v8
    v_exp_f32 v9, v9
    v_exp_f32 v10, v10
    v_exp_f32 v11, v11
    v_exp_f32 v12, v12
    v_exp_f32 v13, v13
    v_exp_f32 v14, v14
    v_exp_f32 v15, v15
    ds_write_b32 v24, v28
    v_cvt_pk_bf16_f32 v30, v8, v10
    v_cvt_pk_bf16_f32 v31, v9, v11
    ds_write2_b32 v25, v30, v31 offset0:0 offset1:2
    v_cvt_pk_bf16_f32 v32, v12, v14
    v_cvt_pk_bf16_f32 v33, v13, v15
    ds_write2_b32 v25, v32, v33 offset0:128 offset1:130
    v_pk_add_f32 v[8:9], v[8:9], v[10:11]
    v_pk_add_f32 v[12:13], v[12:13], v[14:15]
    v_pk_add_f32 v[8:9], v[8:9], v[12:13]
    v_add_f32 v8, v8, v9
    ds_write_b32 v26, v8
    s_waitcnt lgkmcnt(0)
    s_barrier
    s_setprio 0
    v_and_b32 v4, 7, v2
    v_mul_u32_u24 v4, 272, v4
    v_lshrrev_b32 v5, 3, v2
    v_lshl_add_u32 v4, v5, 7, v4
    v_lshl_add_u32 v4, v3, 5, v4
    v_add_u32 v16, 155216, v4
    s_lshl_b32 s59, s80, 6
    s_add_u32 s59, s59, s81
    s_lshl_b32 s59, s59, 10
    s_lshl_b32 s83, s3, 8
    s_add_u32 s59, s59, s83
    s_add_u32 s58, s59, 7340032
    s_add_u32 s59, s59, 7602176
    s_lshl_b32 s56, s81, 15
    s_add_u32 s56, s56, s83
    s_add_u32 s57, s56, 4096
    v_lshlrev_b32 v17, 10, v3
    v_lshl_add_u32 v17, v2, 4, v17
    v_lshlrev_b32 v18, 12, v3
    v_lshl_add_u32 v18, v2, 4, v18
    s_lshl_b32 s48, s80, 16
    s_add_u32 s48, s48, s83
    s_add_u32 s48, s48, 7340032
    s_lshl_b32 s49, s80, 10
    s_add_u32 s49, s49, s83
    s_add_u32 s82, s83, 8192
    v_and_b32 v4, 1, v3
    v_lshlrev_b32 v4, 3, v4
    v_lshl_add_u32 v4, v2, 4, v4
    v_add_u32 v19, s82, v4
    v_and_b32 v4, 1, v2
    v_lshlrev_b32 v4, 4, v4
    v_mov_b32 v5, 0x3f80
    v_lshlrev_b32 v4, v4, v5
    v_bfe_u32 v5, v2, 1, 2
    v_cmp_eq_u32 vcc, 0, v5
    s_nop 1
    v_cndmask_b32 v28, 0, v4, vcc
    v_cmp_eq_u32 vcc, 1, v5
    s_nop 1
    v_cndmask_b32 v29, 0, v4, vcc
    v_cmp_eq_u32 vcc, 2, v5
    s_nop 1
    v_cndmask_b32 v30, 0, v4, vcc
    v_cmp_eq_u32 vcc, 3, v5
    s_nop 1
    v_cndmask_b32 v31, 0, v4, vcc
    s_mov_b32 s65, 0
    buffer_load_dwordx4 v[44:47], v18, s[4:7], s49 offen
    v_lshlrev_b32 v6, 13, v3
    v_lshl_add_u32 v6, v2, 4, v6
    s_lshl_b32 s82, s81, 16
    s_lshl_b32 s83, s3, 8
    s_add_u32 s82, s82, s83
    s_barrier
    s_barrier
    s_add_u32 s83, s82, 0
    buffer_load_dwordx4 v[192:195], v6, s[28:31], s83 offen offset:0
    buffer_load_dwordx4 v[196:199], v6, s[28:31], s83 offen offset:1024
    buffer_load_dwordx4 v[200:203], v6, s[28:31], s83 offen offset:2048
    buffer_load_dwordx4 v[204:207], v6, s[28:31], s83 offen offset:3072
    s_add_u32 s83, s82, 4096
    buffer_load_dwordx4 v[208:211], v6, s[28:31], s83 offen offset:0
    buffer_load_dwordx4 v[212:215], v6, s[28:31], s83 offen offset:1024
    buffer_load_dwordx4 v[216:219], v6, s[28:31], s83 offen offset:2048
    buffer_load_dwordx4 v[220:223], v6, s[28:31], s83 offen offset:3072
    s_add_u32 s83, s82, 32768
    buffer_load_dwordx4 v[224:227], v6, s[28:31], s83 offen offset:0
    buffer_load_dwordx4 v[228:231], v6, s[28:31], s83 offen offset:1024
    buffer_load_dwordx4 v[232:235], v6, s[28:31], s83 offen offset:2048
    buffer_load_dwordx4 v[236:239], v6, s[28:31], s83 offen offset:3072
    s_add_u32 s83, s82, 36864
    buffer_load_dwordx4 v[240:243], v6, s[28:31], s83 offen offset:0
    buffer_load_dwordx4 v[244:247], v6, s[28:31], s83 offen offset:1024
    buffer_load_dwordx4 v[248:251], v6, s[28:31], s83 offen offset:2048
    buffer_load_dwordx4 v[252:255], v6, s[28:31], s83 offen offset:3072
    s_cmp_ge_u32 s3, 2
    s_cbranch_scc1 L_pfw
    v_mul_u32_u24 v5, 3584, v1
    s_mul_i32 s82, s75, 229376
    s_lshl_b32 s83, s74, 7
    s_add_u32 s82, s82, s83
    buffer_load_dword v0, v5, s[32:35], s82 offen
    s_branch L_pfw2
L_pfw:
    s_lshl_b32 s83, s74, 16
    s_lshl_b32 s82, s75, 13
    s_add_u32 s82, s82, s83
    v_lshlrev_b32 v5, 7, v1
    v_lshl_add_u32 v5, s3, 30, v5
    v_xor_b32 v5, 0x80000000, v5
    buffer_load_dword v0, v5, s[36:39], s82 offen
L_pfw2:
    s_waitcnt vmcnt(9)
    v_perm_b32 v128, v196, v192, s77
    v_perm_b32 v132, v196, v192, s78
    v_perm_b32 v129, v204, v200, s77
    v_perm_b32 v133, v204, v200, s78
    v_perm_b32 v130, v212, v208, s77
    v_perm_b32 v134, v212, v208, s78
    v_perm_b32 v131, v220, v216, s77
    v_perm_b32 v135, v220, v216, s78
    v_perm_b32 v136, v197, v193, s77
    v_perm_b32 v140, v197, v193, s78
    v_perm_b32 v137, v205, v201, s77
    v_perm_b32 v141, v205, v201, s78
    v_perm_b32 v138, v213, v209, s77
    v_perm_b32 v142, v213, v209, s78
    v_perm_b32 v139, v221, v217, s77
    v_perm_b32 v143, v221, v217, s78
    v_perm_b32 v144, v198, v194, s77
    v_perm_b32 v148, v198, v194, s78
    v_perm_b32 v145, v206, v202, s77
    v_perm_b32 v149, v206, v202, s78
    v_perm_b32 v146, v214, v210, s77
    v_perm_b32 v150, v214, v210, s78
    v_perm_b32 v147, v222, v218, s77
    v_perm_b32 v151, v222, v218, s78
    v_perm_b32 v152, v199, v195, s77
    v_perm_b32 v156, v199, v195, s78
    v_perm_b32 v153, v207, v203, s77
    v_perm_b32 v157, v207, v203, s78
    v_perm_b32 v154, v215, v211, s77
    v_perm_b32 v158, v215, v211, s78
    v_perm_b32 v155, v223, v219, s77
    v_perm_b32 v159, v223, v219, s78
    s_waitcnt vmcnt(1)
    v_perm_b32 v192, v228, v224, s77
    v_perm_b32 v196, v228, v224, s78
    v_perm_b32 v193, v236, v232, s77
    v_perm_b32 v197, v236, v232, s78
    v_perm_b32 v194, v244, v240, s77
    v_perm_b32 v198, v244, v240, s78
    v_perm_b32 v195, v252, v248, s77
    v_perm_b32 v199, v252, v248, s78
    v_perm_b32 v200, v229, v225, s77
    v_perm_b32 v204, v229, v225, s78
    v_perm_b32 v201, v237, v233, s77
    v_perm_b32 v205, v237, v233, s78
    v_perm_b32 v202, v245, v241, s77
    v_perm_b32 v206, v245, v241, s78
    v_perm_b32 v203, v253, v249, s77
    v_perm_b32 v207, v253, v249, s78
    v_perm_b32 v208, v230, v226, s77
    v_perm_b32 v212, v230, v226, s78
    v_perm_b32 v209, v238, v234, s77
    v_perm_b32 v213, v238, v234, s78
    v_perm_b32 v210, v246, v242, s77
    v_perm_b32 v214, v246, v242, s78
    v_perm_b32 v211, v254, v250, s77
    v_perm_b32 v215, v254, v250, s78
    v_perm_b32 v216, v231, v227, s77
    v_perm_b32 v220, v231, v227, s78
    v_perm_b32 v217, v239, v235, s77
    v_perm_b32 v221, v239, v235, s78
    v_perm_b32 v218, v247, v243, s77
    v_perm_b32 v222, v247, v243, s78
    v_perm_b32 v219, v255, v251, s77
    v_perm_b32 v223, v255, v251, s78
    s_barrier
    ds_read_b128 v[8:11], v16
    ds_read_b128 v[12:15], v16 offset:16
    s_waitcnt lgkmcnt(1)
    v_add_f32_dpp v8, v8, v8 quad_perm:[1,0,3,2] row_mask:0xf bank_mask:0xf
    v_add_f32_dpp v9, v9, v9 quad_perm:[1,0,3,2] row_mask:0xf bank_mask:0xf
    v_add_f32_dpp v10, v10, v10 quad_perm:[1,0,3,2] row_mask:0xf bank_mask:0xf
    v_add_f32_dpp v11, v11, v11 quad_perm:[1,0,3,2] row_mask:0xf bank_mask:0xf
    s_waitcnt lgkmcnt(0)
    v_add_f32_dpp v12, v12, v12 quad_perm:[1,0,3,2] row_mask:0xf bank_mask:0xf
    v_add_f32_dpp v13, v13, v13 quad_perm:[1,0,3,2] row_mask:0xf bank_mask:0xf
    v_add_f32_dpp v14, v14, v14 quad_perm:[1,0,3,2] row_mask:0xf bank_mask:0xf
    v_add_f32_dpp v15, v15, v15 quad_perm:[1,0,3,2] row_mask:0xf bank_mask:0xf
    v_add_f32_dpp v8, v8, v8 quad_perm:[2,3,0,1] row_mask:0xf bank_mask:0xf
    v_add_f32_dpp v9, v9, v9 quad_perm:[2,3,0,1] row_mask:0xf bank_mask:0xf
    v_add_f32_dpp v10, v10, v10 quad_perm:[2,3,0,1] row_mask:0xf bank_mask:0xf
    v_add_f32_dpp v11, v11, v11 quad_perm:[2,3,0,1] row_mask:0xf bank_mask:0xf
    v_add_f32_dpp v12, v12, v12 quad_perm:[2,3,0,1] row_mask:0xf bank_mask:0xf
    v_add_f32_dpp v13, v13, v13 quad_perm:[2,3,0,1] row_mask:0xf bank_mask:0xf
    v_add_f32_dpp v14, v14, v14 quad_perm:[2,3,0,1] row_mask:0xf bank_mask:0xf
    v_add_f32_dpp v15, v15, v15 quad_perm:[2,3,0,1] row_mask:0xf bank_mask:0xf
    v_add_f32_dpp v8, v8, v8 row_half_mirror row_mask:0xf bank_mask:0xf
    v_add_f32_dpp v9, v9, v9 row_half_mirror row_mask:0xf bank_mask:0xf
    v_add_f32_dpp v10, v10, v10 row_half_mirror row_mask:0xf bank_mask:0xf
    v_add_f32_dpp v11, v11, v11 row_half_mirror row_mask:0xf bank_mask:0xf
    v_add_f32_dpp v12, v12, v12 row_half_mirror row_mask:0xf bank_mask:0xf
    v_add_f32_dpp v13, v13, v13 row_half_mirror row_mask:0xf bank_mask:0xf
    v_add_f32_dpp v14, v14, v14 row_half_mirror row_mask:0xf bank_mask:0xf
    v_add_f32_dpp v15, v15, v15 row_half_mirror row_mask:0xf bank_mask:0xf
    v_cvt_pk_bf16_f32 v20, v8, v9
    v_cvt_pk_bf16_f32 v21, v10, v11
    v_cvt_pk_bf16_f32 v22, v12, v13
    v_cvt_pk_bf16_f32 v23, v14, v15
    v_mov_b32_dpp v24, v20 row_ror:8 row_mask:0xf bank_mask:0xf
    v_mov_b32_dpp v25, v21 row_ror:8 row_mask:0xf bank_mask:0xf
    v_mov_b32_dpp v26, v22 row_ror:8 row_mask:0xf bank_mask:0xf
    v_mov_b32_dpp v27, v23 row_ror:8 row_mask:0xf bank_mask:0xf
    v_mfma_f32_16x16x32_bf16 v[64:67], v[20:23], v[128:131], 0
    v_mfma_f32_16x16x32_bf16 v[68:71], v[20:23], v[132:135], 0
    v_mfma_f32_16x16x32_bf16 v[72:75], v[20:23], v[136:139], 0
    v_mfma_f32_16x16x32_bf16 v[76:79], v[20:23], v[140:143], 0
    v_mfma_f32_16x16x32_bf16 v[80:83], v[20:23], v[144:147], 0
    v_mfma_f32_16x16x32_bf16 v[84:87], v[20:23], v[148:151], 0
    v_mfma_f32_16x16x32_bf16 v[88:91], v[20:23], v[152:155], 0
    v_mfma_f32_16x16x32_bf16 v[92:95], v[20:23], v[156:159], 0
    v_mfma_f32_16x16x32_bf16 v[64:67], v[24:27], v[192:195], v[64:67]
    v_mfma_f32_16x16x32_bf16 v[68:71], v[24:27], v[196:199], v[68:71]
    v_mfma_f32_16x16x32_bf16 v[72:75], v[24:27], v[200:203], v[72:75]
    v_mfma_f32_16x16x32_bf16 v[76:79], v[24:27], v[204:207], v[76:79]
    v_mfma_f32_16x16x32_bf16 v[80:83], v[24:27], v[208:211], v[80:83]
    v_mfma_f32_16x16x32_bf16 v[84:87], v[24:27], v[212:215], v[84:87]
    v_mfma_f32_16x16x32_bf16 v[88:91], v[24:27], v[216:219], v[88:91]
    v_mfma_f32_16x16x32_bf16 v[92:95], v[24:27], v[220:223], v[92:95]
    s_mov_b64 exec, 0xffff
    s_nop 0
    v_cvt_pk_bf16_f32 v8, v64, v68
    s_nop 0
    v_cvt_pk_bf16_f32 v9, v72, v76
    s_nop 0
    v_cvt_pk_bf16_f32 v10, v80, v84
    s_nop 0
    v_cvt_pk_bf16_f32 v11, v88, v92
    buffer_store_dwordx4 v[8:11], v7, s[20:23], s58 offen sc1
    s_mov_b64 exec, -1
    s_cmp_ge_u32 s74, 28
    s_cbranch_scc1 L_fin
    s_branch L_f03
L_p45b:
    v_lshrrev_b32 v4, 3, v2
    v_lshlrev_b32 v4, 3, v4
    v_add_u32 v4, v4, v3
    v_lshlrev_b32 v4, 15, v4
    v_and_b32 v5, 7, v2
    v_lshl_add_u32 v6, v5, 4, v4
    s_lshl_b32 s82, s56, 20
    s_lshl_b32 s83, s81, 7
    s_add_u32 s82, s82, s83
    s_add_u32 s83, s82, 0
    buffer_load_dwordx4 v[192:195], v6, s[24:27], s83 offen
    s_add_u32 s83, s82, 8192
    buffer_load_dwordx4 v[196:199], v6, s[24:27], s83 offen
    s_add_u32 s83, s82, 16384
    buffer_load_dwordx4 v[200:203], v6, s[24:27], s83 offen
    s_add_u32 s83, s82, 24576
    buffer_load_dwordx4 v[204:207], v6, s[24:27], s83 offen
    s_add_u32 s83, s82, 131072
    buffer_load_dwordx4 v[208:211], v6, s[24:27], s83 offen
    s_add_u32 s83, s82, 139264
    buffer_load_dwordx4 v[212:215], v6, s[24:27], s83 offen
    s_add_u32 s83, s82, 147456
    buffer_load_dwordx4 v[216:219], v6, s[24:27], s83 offen
    s_add_u32 s83, s82, 155648
    buffer_load_dwordx4 v[220:223], v6, s[24:27], s83 offen
    s_add_u32 s83, s82, 524288
    buffer_load_dwordx4 v[224:227], v6, s[24:27], s83 offen
    s_add_u32 s83, s82, 532480
    buffer_load_dwordx4 v[228:231], v6, s[24:27], s83 offen
    s_add_u32 s83, s82, 540672
    buffer_load_dwordx4 v[232:235], v6, s[24:27], s83 offen
    s_add_u32 s83, s82, 548864
    buffer_load_dwordx4 v[236:239], v6, s[24:27], s83 offen
    s_add_u32 s83, s82, 655360
    buffer_load_dwordx4 v[240:243], v6, s[24:27], s83 offen
    s_add_u32 s83, s82, 663552
    buffer_load_dwordx4 v[244:247], v6, s[24:27], s83 offen
    s_add_u32 s83, s82, 671744
    buffer_load_dwordx4 v[248:251], v6, s[24:27], s83 offen
    s_add_u32 s83, s82, 679936
    buffer_load_dwordx4 v[252:255], v6, s[24:27], s83 offen
    v_and_b32 v4, 7, v2
    v_lshl_add_u32 v4, v4, 2, v3
    v_lshlrev_b32 v17, 11, v4
    s_lshl_b32 s58, s80, 16
    s_lshr_b32 s83, s74, 4
    s_lshl_b32 s83, s83, 10
    s_add_u32 s58, s58, s83
    s_lshl_b32 s83, s56, 8
    s_add_u32 s58, s58, s83
    s_and_b32 s83, s74, 15
    s_lshl_b32 s83, s83, 4
    s_add_u32 s58, s58, s83
    s_add_u32 s58, s58, 6291456
    v_lshlrev_b32 v16, 10, v3
    v_lshl_add_u32 v16, v2, 4, v16
    s_lshl_b32 s57, s74, 2
    s_add_u32 s57, s57, s80
    s_lshl_b32 s57, s57, 15
    s_lshl_b32 s83, s56, 8
    s_add_u32 s57, s57, s83
    s_add_u32 s57, s57, 2097152
    v_and_b32 v4, 1, v2
    v_lshlrev_b32 v4, 4, v4
    v_mov_b32 v5, 0xffff
    v_lshlrev_b32 v4, v4, v5
    v_bfe_u32 v5, v2, 1, 2
    v_cmp_eq_u32 vcc, 0, v5
    s_nop 1
    v_cndmask_b32 v12, 0, v4, vcc
    v_cmp_eq_u32 vcc, 1, v5
    s_nop 1
    v_cndmask_b32 v13, 0, v4, vcc
    v_cmp_eq_u32 vcc, 2, v5
    s_nop 1
    v_cndmask_b32 v14, 0, v4, vcc
    v_cmp_eq_u32 vcc, 3, v5
    s_nop 1
    v_cndmask_b32 v15, 0, v4, vcc
    s_lshl_b32 s82, s56, 8
    s_add_u32 s82, s82, 154192
    v_and_b32 v4, 1, v3
    v_lshlrev_b32 v4, 3, v4
    v_lshl_add_u32 v4, v2, 4, v4
    v_add_u32 v18, s82, v4
    v_and_b32 v4, 4, v2
    v_add_u32 v4, v4, v3
    v_lshl_add_u32 v19, v4, 4, s82
    s_mul_i32 s82, s56, 544
    s_add_u32 s82, s82, 155216
    v_lshrrev_b32 v4, 3, v2
    v_mul_u32_u24 v4, 272, v4
    v_and_b32 v5, 7, v2
    v_lshl_add_u32 v4, v5, 5, v4
    v_lshrrev_b32 v5, 1, v3
    v_lshl_add_u32 v4, v5, 4, v4
    v_add_u32 v20, s82, v4
    s_mov_b32 s48, 0x00ff00ff
    s_mov_b32 s49, 0x00ff00ff
    s_mov_b32 s50, 0
    s_mov_b32 s51, -1
    s_mov_b32 s79, 0
    s_waitcnt vmcnt(8)
    v_perm_b32 v128, v196, v192, s77
    v_perm_b32 v132, v196, v192, s78
    v_perm_b32 v129, v204, v200, s77
    v_perm_b32 v133, v204, v200, s78
    v_perm_b32 v130, v212, v208, s77
    v_perm_b32 v134, v212, v208, s78
    v_perm_b32 v131, v220, v216, s77
    v_perm_b32 v135, v220, v216, s78
    v_perm_b32 v136, v197, v193, s77
    v_perm_b32 v140, v197, v193, s78
    v_perm_b32 v137, v205, v201, s77
    v_perm_b32 v141, v205, v201, s78
    v_perm_b32 v138, v213, v209, s77
    v_perm_b32 v142, v213, v209, s78
    v_perm_b32 v139, v221, v217, s77
    v_perm_b32 v143, v221, v217, s78
    v_perm_b32 v144, v198, v194, s77
    v_perm_b32 v148, v198, v194, s78
    v_perm_b32 v145, v206, v202, s77
    v_perm_b32 v149, v206, v202, s78
    v_perm_b32 v146, v214, v210, s77
    v_perm_b32 v150, v214, v210, s78
    v_perm_b32 v147, v222, v218, s77
    v_perm_b32 v151, v222, v218, s78
    v_perm_b32 v152, v199, v195, s77
    v_perm_b32 v156, v199, v195, s78
    v_perm_b32 v153, v207, v203, s77
    v_perm_b32 v157, v207, v203, s78
    v_perm_b32 v154, v215, v211, s77
    v_perm_b32 v158, v215, v211, s78
    v_perm_b32 v155, v223, v219, s77
    v_perm_b32 v159, v223, v219, s78
    buffer_load_dwordx4 v[96:99], v17, s[20:23], s58 offen sc1
    s_waitcnt vmcnt(1)
    v_perm_b32 v192, v228, v224, s77
    v_perm_b32 v196, v228, v224, s78
    v_perm_b32 v193, v236, v232, s77
    v_perm_b32 v197, v236, v232, s78
    v_perm_b32 v194, v244, v240, s77
    v_perm_b32 v198, v244, v240, s78
    v_perm_b32 v195, v252, v248, s77
    v_perm_b32 v199, v252, v248, s78
    v_perm_b32 v200, v229, v225, s77
    v_perm_b32 v204, v229, v225, s78
    v_perm_b32 v201, v237, v233, s77
    v_perm_b32 v205, v237, v233, s78
    v_perm_b32 v202, v245, v241, s77
    v_perm_b32 v206, v245, v241, s78
    v_perm_b32 v203, v253, v249, s77
    v_perm_b32 v207, v253, v249, s78
    v_perm_b32 v208, v230, v226, s77
    v_perm_b32 v212, v230, v226, s78
    v_perm_b32 v209, v238, v234, s77
    v_perm_b32 v213, v238, v234, s78
    v_perm_b32 v210, v246, v242, s77
    v_perm_b32 v214, v246, v242, s78
    v_perm_b32 v211, v254, v250, s77
    v_perm_b32 v215, v254, v250, s78
    v_perm_b32 v216, v231, v227, s77
    v_perm_b32 v220, v231, v227, s78
    v_perm_b32 v217, v239, v235, s77
    v_perm_b32 v221, v239, v235, s78
    v_perm_b32 v218, v247, v243, s77
    v_perm_b32 v222, v247, v243, s78
    v_perm_b32 v219, v255, v251, s77
    v_perm_b32 v223, v255, v251, s78
    s_mov_b32 s65, 0
    s_mov_b32 s59, 0
    s_mov_b32 s52, 0
L_recpoll:
    s_waitcnt vmcnt(0)
    v_cmp_ne_u32 vcc, s76, v99
    s_cbranch_vccz L_recok
    s_sleep 2
    buffer_load_dwordx4 v[96:99], v17, s[20:23], s58 offen sc1
    s_add_u32 s65, s65, 1
    s_cmp_lt_u32 s65, 200000
    s_cbranch_scc1 L_recpoll
    v_mov_b32 v4, 7
    v_mov_b32 v5, 0
    buffer_store_dword v4, v5, s[44:47], 0 offen offset:28
    s_waitcnt vmcnt(0)
L_recok:
    s_add_u32 s83, s57, 0
    buffer_load_dwordx4 v[64:67], v16, s[20:23], s83 offen sc1
    s_add_u32 s83, s57, 4096
    buffer_load_dwordx4 v[68:71], v16, s[20:23], s83 offen sc1
    s_add_u32 s83, s57, 8192
    buffer_load_dwordx4 v[72:75], v16, s[20:23], s83 offen sc1
    s_add_u32 s83, s57, 12288
    buffer_load_dwordx4 v[76:79], v16, s[20:23], s83 offen sc1
    s_add_u32 s83, s57, 16384
    buffer_load_dwordx4 v[80:83], v16, s[20:23], s83 offen sc1
    s_add_u32 s83, s57, 20480
    buffer_load_dwordx4 v[84:87], v16, s[20:23], s83 offen sc1
    s_add_u32 s83, s57, 24576
    buffer_load_dwordx4 v[88:91], v16, s[20:23], s83 offen sc1
    s_add_u32 s83, s57, 28672
    buffer_load_dwordx4 v[92:95], v16, s[20:23], s83 offen sc1
L_payj:
    s_cmp_lg_u32 s59, 0
    s_cbranch_scc1 L_nob9
    s_mov_b32 s59, 1
    s_barrier
L_nob9:
    v_max_f32_dpp v24, v96, v96 quad_perm:[1,0,3,2] row_mask:0xf bank_mask:0xf
    v_bitop3_b32 v26, v96, v97, v98 bitop3:0x96
    s_nop 0
    v_max_f32_dpp v24, v24, v24 quad_perm:[2,3,0,1] row_mask:0xf bank_mask:0xf
    v_cndmask_b32 v26, 0, v26, s[48:49]
    s_nop 0
    v_max_f32_dpp v24, v24, v24 row_half_mirror row_mask:0xf bank_mask:0xf
    v_mov_b32 v25, v24
    s_nop 1
    v_permlane16_swap_b32 v24, v25
    v_max_f32 v24, v24, v25
    v_mov_b32 v25, v24
    s_nop 1
    v_permlane32_swap_b32 v24, v25
    v_max_f32 v24, v24, v25
    v_sub_f32 v24, v96, v24
    v_exp_f32 v24, v24
    s_nop 0
    v_mul_f32 v25, v24, v97
    s_nop 1
    v_add_f32_dpp v25, v25, v25 quad_perm:[1,0,3,2] row_mask:0xf bank_mask:0xf
    s_nop 1
    v_add_f32_dpp v25, v25, v25 quad_perm:[2,3,0,1] row_mask:0xf bank_mask:0xf
    s_nop 1
    v_add_f32_dpp v25, v25, v25 row_half_mirror row_mask:0xf bank_mask:0xf
    v_mov_b32 v27, v25
    s_nop 1
    v_permlane16_swap_b32 v25, v27
    v_add_f32 v25, v25, v27
    v_mov_b32 v27, v25
    s_nop 1
    v_permlane32_swap_b32 v25, v27
    v_add_f32 v25, v25, v27
    v_rcp_f32 v25, v25
    s_nop 0
    v_mul_f32 v24, v24, v25
    v_cvt_pk_bf16_f32 v24, v24, v24
    s_nop 1
    v_and_b32_dpp v160, v24, v12 row_newbcast:0 row_mask:0xf bank_mask:0xf
    v_and_b32_dpp v161, v24, v13 row_newbcast:0 row_mask:0xf bank_mask:0xf
    v_and_b32_dpp v162, v24, v14 row_newbcast:0 row_mask:0xf bank_mask:0xf
    v_and_b32_dpp v163, v24, v15 row_newbcast:0 row_mask:0xf bank_mask:0xf
    v_and_b32_dpp v164, v24, v12 row_newbcast:1 row_mask:0xf bank_mask:0xf
    v_and_b32_dpp v165, v24, v13 row_newbcast:1 row_mask:0xf bank_mask:0xf
    v_and_b32_dpp v166, v24, v14 row_newbcast:1 row_mask:0xf bank_mask:0xf
    v_and_b32_dpp v167, v24, v15 row_newbcast:1 row_mask:0xf bank_mask:0xf
    v_and_b32_dpp v168, v24, v12 row_newbcast:2 row_mask:0xf bank_mask:0xf
    v_and_b32_dpp v169, v24, v13 row_newbcast:2 row_mask:0xf bank_mask:0xf
    v_and_b32_dpp v170, v24, v14 row_newbcast:2 row_mask:0xf bank_mask:0xf
    v_and_b32_dpp v171, v24, v15 row_newbcast:2 row_mask:0xf bank_mask:0xf
    v_and_b32_dpp v172, v24, v12 row_newbcast:3 row_mask:0xf bank_mask:0xf
    v_and_b32_dpp v173, v24, v13 row_newbcast:3 row_mask:0xf bank_mask:0xf
    v_and_b32_dpp v174, v24, v14 row_newbcast:3 row_mask:0xf bank_mask:0xf
    v_and_b32_dpp v175, v24, v15 row_newbcast:3 row_mask:0xf bank_mask:0xf
    v_and_b32_dpp v176, v24, v12 row_newbcast:4 row_mask:0xf bank_mask:0xf
    v_and_b32_dpp v177, v24, v13 row_newbcast:4 row_mask:0xf bank_mask:0xf
    v_and_b32_dpp v178, v24, v14 row_newbcast:4 row_mask:0xf bank_mask:0xf
    v_and_b32_dpp v179, v24, v15 row_newbcast:4 row_mask:0xf bank_mask:0xf
    v_and_b32_dpp v180, v24, v12 row_newbcast:5 row_mask:0xf bank_mask:0xf
    v_and_b32_dpp v181, v24, v13 row_newbcast:5 row_mask:0xf bank_mask:0xf
    v_and_b32_dpp v182, v24, v14 row_newbcast:5 row_mask:0xf bank_mask:0xf
    v_and_b32_dpp v183, v24, v15 row_newbcast:5 row_mask:0xf bank_mask:0xf
    v_and_b32_dpp v184, v24, v12 row_newbcast:6 row_mask:0xf bank_mask:0xf
    v_and_b32_dpp v185, v24, v13 row_newbcast:6 row_mask:0xf bank_mask:0xf
    v_and_b32_dpp v186, v24, v14 row_newbcast:6 row_mask:0xf bank_mask:0xf
    v_and_b32_dpp v187, v24, v15 row_newbcast:6 row_mask:0xf bank_mask:0xf
    v_and_b32_dpp v188, v24, v12 row_newbcast:7 row_mask:0xf bank_mask:0xf
    v_and_b32_dpp v189, v24, v13 row_newbcast:7 row_mask:0xf bank_mask:0xf
    v_and_b32_dpp v190, v24, v14 row_newbcast:7 row_mask:0xf bank_mask:0xf
    v_and_b32_dpp v191, v24, v15 row_newbcast:7 row_mask:0xf bank_mask:0xf
    s_waitcnt vmcnt(7)
    v_mfma_f32_16x16x32_bf16 v[8:11], v[160:163], v[64:67], 0
    s_waitcnt vmcnt(6)
    v_mfma_f32_16x16x32_bf16 v[8:11], v[164:167], v[68:71], v[8:11]
    v_bitop3_b32 v26, v26, v64, v65 bitop3:0x96
    v_bitop3_b32 v26, v26, v66, v67 bitop3:0x96
    s_waitcnt vmcnt(5)
    v_mfma_f32_16x16x32_bf16 v[8:11], v[168:171], v[72:75], v[8:11]
    v_bitop3_b32 v26, v26, v68, v69 bitop3:0x96
    v_bitop3_b32 v26, v26, v70, v71 bitop3:0x96
    s_waitcnt vmcnt(4)
    v_mfma_f32_16x16x32_bf16 v[8:11], v[172:175], v[76:79], v[8:11]
    v_bitop3_b32 v26, v26, v72, v73 bitop3:0x96
    v_bitop3_b32 v26, v26, v74, v75 bitop3:0x96
    s_waitcnt vmcnt(3)
    v_mfma_f32_16x16x32_bf16 v[8:11], v[176:179], v[80:83], v[8:11]
    v_bitop3_b32 v26, v26, v76, v77 bitop3:0x96
    v_bitop3_b32 v26, v26, v78, v79 bitop3:0x96
    s_waitcnt vmcnt(2)
    v_mfma_f32_16x16x32_bf16 v[8:11], v[180:183], v[84:87], v[8:11]
    v_bitop3_b32 v26, v26, v80, v81 bitop3:0x96
    v_bitop3_b32 v26, v26, v82, v83 bitop3:0x96
    s_waitcnt vmcnt(1)
    v_mfma_f32_16x16x32_bf16 v[8:11], v[184:187], v[88:91], v[8:11]
    v_bitop3_b32 v26, v26, v84, v85 bitop3:0x96
    v_bitop3_b32 v26, v26, v86, v87 bitop3:0x96
    s_waitcnt vmcnt(0)
    v_mfma_f32_16x16x32_bf16 v[8:11], v[188:191], v[92:95], v[8:11]
    v_bitop3_b32 v26, v26, v88, v89 bitop3:0x96
    v_bitop3_b32 v26, v26, v90, v91 bitop3:0x96
    v_bitop3_b32 v26, v26, v92, v93 bitop3:0x96
    v_bitop3_b32 v26, v26, v94, v95 bitop3:0x96
    s_nop 1
    v_xor_b32_dpp v26, v26, v26 quad_perm:[1,0,3,2] row_mask:0xf bank_mask:0xf
    s_nop 0
    v_cvt_pk_bf16_f32 v4, v8, v9
    v_cvt_pk_bf16_f32 v5, v10, v11
    ds_write_b64 v18, v[4:5]
    ds_read_b128 v[100:103], v19
    ds_read_b128 v[104:107], v19 offset:128
    v_xor_b32_dpp v26, v26, v26 quad_perm:[2,3,0,1] row_mask:0xf bank_mask:0xf
    s_nop 1
    v_xor_b32_dpp v26, v26, v26 row_half_mirror row_mask:0xf bank_mask:0xf
    s_nop 1
    v_xor_b32_dpp v26, v26, v26 row_mirror row_mask:0xf bank_mask:0xf
    v_mov_b32 v27, v26
    s_nop 1
    v_permlane16_swap_b32 v26, v27
    v_xor_b32 v26, v26, v27
    v_mov_b32 v27, v26
    s_nop 1
    v_permlane32_swap_b32 v26, v27
    v_xor_b32 v26, v26, v27
    v_cmp_ne_u32 vcc, 0, v26
    s_waitcnt lgkmcnt(1)
    v_mfma_f32_16x16x32_bf16 v[32:35], v[100:103], v[128:131], 0
    v_mfma_f32_16x16x32_bf16 v[36:39], v[100:103], v[132:135], 0
    v_mfma_f32_16x16x32_bf16 v[40:43], v[100:103], v[136:139], 0
    v_mfma_f32_16x16x32_bf16 v[44:47], v[100:103], v[140:143], 0
    v_mfma_f32_16x16x32_bf16 v[48:51], v[100:103], v[144:147], 0
    v_mfma_f32_16x16x32_bf16 v[52:55], v[100:103], v[148:151], 0
    v_mfma_f32_16x16x32_bf16 v[56:59], v[100:103], v[152:155], 0
    v_mfma_f32_16x16x32_bf16 v[60:63], v[100:103], v[156:159], 0
    s_cbranch_vccz L_h3ok
    s_add_u32 s79, s79, 1
    s_cmp_ge_u32 s79, 200000
    s_cbranch_scc1 L_h3fail
    s_sleep 2
    s_waitcnt lgkmcnt(0)
    s_mov_b32 s52, 0
    buffer_load_dwordx4 v[96:99], v17, s[20:23], s58 offen sc1
    s_branch L_recpoll
L_h3fail:
    v_mov_b32 v4, 3
    v_mov_b32 v5, 0
    buffer_store_dword v4, v5, s[44:47], 0 offen offset:12
L_h3ok:
    s_waitcnt lgkmcnt(0)
    v_mfma_f32_16x16x32_bf16 v[32:35], v[104:107], v[192:195], v[32:35]
    v_mfma_f32_16x16x32_bf16 v[36:39], v[104:107], v[196:199], v[36:39]
    v_mfma_f32_16x16x32_bf16 v[40:43], v[104:107], v[200:203], v[40:43]
    v_mfma_f32_16x16x32_bf16 v[44:47], v[104:107], v[204:207], v[44:47]
    v_mfma_f32_16x16x32_bf16 v[48:51], v[104:107], v[208:211], v[48:51]
    v_mfma_f32_16x16x32_bf16 v[52:55], v[104:107], v[212:215], v[52:55]
    v_mfma_f32_16x16x32_bf16 v[56:59], v[104:107], v[216:219], v[56:59]
    v_mfma_f32_16x16x32_bf16 v[60:63], v[104:107], v[220:223], v[60:63]
    s_nop 4
    v_cndmask_b32 v8, v32, v48, s[50:51]
    v_cndmask_b32 v9, v36, v52, s[50:51]
    v_cndmask_b32 v10, v40, v56, s[50:51]
    v_cndmask_b32 v11, v44, v60, s[50:51]
    s_mov_b32 exec_lo, 0xff0000ff
    s_mov_b32 exec_hi, 0xff0000ff
    ds_write_b128 v20, v[8:11]
    s_mov_b64 exec, -1
    s_waitcnt lgkmcnt(0)
    s_barrier
    s_setprio 0
    v_and_b32 v4, 12, v2
    v_add_u32 v4, v4, v3
    v_mul_u32_u24 v4, 28672, v4
    v_and_b32 v5, 3, v2
    v_lshl_add_u32 v6, v5, 4, v4
    s_lshr_b32 s82, s56, 1
    s_mul_i32 s82, s82, 917504
    s_lshl_b32 s83, s81, 6
    s_add_u32 s82, s82, s83
    s_cmp_ge_u32 s74, 28
    s_cbranch_scc1 L_fin
    s_barrier
    s_add_u32 s83, s82, 0
    buffer_load_dwordx4 v[192:195], v6, s[32:35], s83 offen
    s_add_u32 s83, s82, 3584
    buffer_load_dwordx4 v[196:199], v6, s[32:35], s83 offen
    s_add_u32 s83, s82, 7168
    buffer_load_dwordx4 v[200:203], v6, s[32:35], s83 offen
    s_add_u32 s83, s82, 10752
    buffer_load_dwordx4 v[204:207], v6, s[32:35], s83 offen
    s_add_u32 s83, s82, 14336
    buffer_load_dwordx4 v[208:211], v6, s[32:35], s83 offen
    s_add_u32 s83, s82, 17920
    buffer_load_dwordx4 v[212:215], v6, s[32:35], s83 offen
    s_add_u32 s83, s82, 21504
    buffer_load_dwordx4 v[216:219], v6, s[32:35], s83 offen
    s_add_u32 s83, s82, 25088
    buffer_load_dwordx4 v[220:223], v6, s[32:35], s83 offen
    s_add_u32 s83, s82, 458752
    buffer_load_dwordx4 v[224:227], v6, s[32:35], s83 offen
    s_add_u32 s83, s82, 462336
    buffer_load_dwordx4 v[228:231], v6, s[32:35], s83 offen
    s_add_u32 s83, s82, 465920
    buffer_load_dwordx4 v[232:235], v6, s[32:35], s83 offen
    s_add_u32 s83, s82, 469504
    buffer_load_dwordx4 v[236:239], v6, s[32:35], s83 offen
    s_add_u32 s83, s82, 473088
    buffer_load_dwordx4 v[240:243], v6, s[32:35], s83 offen
    s_add_u32 s83, s82, 476672
    buffer_load_dwordx4 v[244:247], v6, s[32:35], s83 offen
    s_add_u32 s83, s82, 480256
    buffer_load_dwordx4 v[248:251], v6, s[32:35], s83 offen
    s_add_u32 s83, s82, 483840
    buffer_load_dwordx4 v[252:255], v6, s[32:35], s83 offen
    s_lshr_b32 s82, s56, 1
    s_lshl_b32 s83, s82, 9
    s_add_u32 s83, s83, 8192
    v_and_b32 v4, 12, v2
    v_add_u32 v4, v4, v3
    v_lshl_add_u32 v21, v4, 4, s83
    s_lshl_b32 s82, s82, 10
    s_and_b32 s83, s3, 1
    s_lshl_b32 s83, s83, 7
    s_add_u32 s82, s82, s83
    s_add_u32 s82, s82, 0
    v_and_b32 v4, 3, v2
    v_lshlrev_b32 v4, 5, v4
    v_lshl_add_u32 v4, v3, 8, v4
    v_add_u32 v22, s82, v4
    v_add_u32 v23, 2048, v22
    v_mov_b32 v8, 0x3f803f80
    v_mov_b32 v9, 0x3f803f80
    v_mov_b32 v10, 0x3f803f80
    v_mov_b32 v11, 0x3f803f80
    s_waitcnt vmcnt(8)
    v_perm_b32 v128, v196, v192, s77
    v_perm_b32 v132, v196, v192, s78
    v_perm_b32 v129, v204, v200, s77
    v_perm_b32 v133, v204, v200, s78
    v_perm_b32 v130, v212, v208, s77
    v_perm_b32 v134, v212, v208, s78
    v_perm_b32 v131, v220, v216, s77
    v_perm_b32 v135, v220, v216, s78
    v_perm_b32 v136, v197, v193, s77
    v_perm_b32 v140, v197, v193, s78
    v_perm_b32 v137, v205, v201, s77
    v_perm_b32 v141, v205, v201, s78
    v_perm_b32 v138, v213, v209, s77
    v_perm_b32 v142, v213, v209, s78
    v_perm_b32 v139, v221, v217, s77
    v_perm_b32 v143, v221, v217, s78
    v_perm_b32 v144, v198, v194, s77
    v_perm_b32 v148, v198, v194, s78
    v_perm_b32 v145, v206, v202, s77
    v_perm_b32 v149, v206, v202, s78
    v_perm_b32 v146, v214, v210, s77
    v_perm_b32 v150, v214, v210, s78
    v_perm_b32 v147, v222, v218, s77
    v_perm_b32 v151, v222, v218, s78
    v_perm_b32 v152, v199, v195, s77
    v_perm_b32 v156, v199, v195, s78
    v_perm_b32 v153, v207, v203, s77
    v_perm_b32 v157, v207, v203, s78
    v_perm_b32 v154, v215, v211, s77
    v_perm_b32 v158, v215, v211, s78
    v_perm_b32 v155, v223, v219, s77
    v_perm_b32 v159, v223, v219, s78
    v_mfma_f32_16x16x32_bf16 v[64:67], v[8:11], v[128:131], 0
    v_mfma_f32_16x16x32_bf16 v[68:71], v[8:11], v[132:135], 0
    v_mfma_f32_16x16x32_bf16 v[72:75], v[8:11], v[136:139], 0
    v_mfma_f32_16x16x32_bf16 v[76:79], v[8:11], v[140:143], 0
    v_mfma_f32_16x16x32_bf16 v[80:83], v[8:11], v[144:147], 0
    v_mfma_f32_16x16x32_bf16 v[84:87], v[8:11], v[148:151], 0
    v_mfma_f32_16x16x32_bf16 v[88:91], v[8:11], v[152:155], 0
    v_mfma_f32_16x16x32_bf16 v[92:95], v[8:11], v[156:159], 0
    s_waitcnt vmcnt(0)
    v_perm_b32 v192, v228, v224, s77
    v_perm_b32 v196, v228, v224, s78
    v_perm_b32 v193, v236, v232, s77
    v_perm_b32 v197, v236, v232, s78
    v_perm_b32 v194, v244, v240, s77
    v_perm_b32 v198, v244, v240, s78
    v_perm_b32 v195, v252, v248, s77
    v_perm_b32 v199, v252, v248, s78
    v_perm_b32 v200, v229, v225, s77
    v_perm_b32 v204, v229, v225, s78
    v_perm_b32 v201, v237, v233, s77
    v_perm_b32 v205, v237, v233, s78
    v_perm_b32 v202, v245, v241, s77
    v_perm_b32 v206, v245, v241, s78
    v_perm_b32 v203, v253, v249, s77
    v_perm_b32 v207, v253, v249, s78
    v_perm_b32 v208, v230, v226, s77
    v_perm_b32 v212, v230, v226, s78
    v_perm_b32 v209, v238, v234, s77
    v_perm_b32 v213, v238, v234, s78
    v_perm_b32 v210, v246, v242, s77
    v_perm_b32 v214, v246, v242, s78
    v_perm_b32 v211, v254, v250, s77
    v_perm_b32 v215, v254, v250, s78
    v_perm_b32 v216, v231, v227, s77
    v_perm_b32 v220, v231, v227, s78
    v_perm_b32 v217, v239, v235, s77
    v_perm_b32 v221, v239, v235, s78
    v_perm_b32 v218, v247, v243, s77
    v_perm_b32 v222, v247, v243, s78
    v_perm_b32 v219, v255, v251, s77
    v_perm_b32 v223, v255, v251, s78
    v_mfma_f32_16x16x32_bf16 v[64:67], v[8:11], v[192:195], v[64:67]
    v_mfma_f32_16x16x32_bf16 v[68:71], v[8:11], v[196:199], v[68:71]
    v_mfma_f32_16x16x32_bf16 v[72:75], v[8:11], v[200:203], v[72:75]
    v_mfma_f32_16x16x32_bf16 v[76:79], v[8:11], v[204:207], v[76:79]
    v_mfma_f32_16x16x32_bf16 v[80:83], v[8:11], v[208:211], v[80:83]
    v_mfma_f32_16x16x32_bf16 v[84:87], v[8:11], v[212:215], v[84:87]
    v_mfma_f32_16x16x32_bf16 v[88:91], v[8:11], v[216:219], v[88:91]
    v_mfma_f32_16x16x32_bf16 v[92:95], v[8:11], v[220:223], v[92:95]
    s_mov_b32 exec_lo, 0x00f0000f
    s_mov_b32 exec_hi, 0xf0000f00
    ds_write2_b32 v23, v64, v68 offset0:0 offset1:1
    s_nop 0
    ds_write2_b32 v23, v72, v76 offset0:2 offset1:3
    s_nop 0
    ds_write2_b32 v23, v80, v84 offset0:4 offset1:5
    s_nop 0
    ds_write2_b32 v23, v88, v92 offset0:6 offset1:7
    s_mov_b64 exec, -1
    s_waitcnt lgkmcnt(0)
    s_setprio 1
    s_barrier
    ds_read_b128 v[100:103], v21
    ds_read_b128 v[104:107], v21 offset:256
    s_waitcnt lgkmcnt(1)
    v_mfma_f32_16x16x32_bf16 v[64:67], v[100:103], v[128:131], 0
    v_mfma_f32_16x16x32_bf16 v[68:71], v[100:103], v[132:135], 0
    v_mfma_f32_16x16x32_bf16 v[72:75], v[100:103], v[136:139], 0
    v_mfma_f32_16x16x32_bf16 v[76:79], v[100:103], v[140:143], 0
    v_mfma_f32_16x16x32_bf16 v[80:83], v[100:103], v[144:147], 0
    v_mfma_f32_16x16x32_bf16 v[84:87], v[100:103], v[148:151], 0
    v_mfma_f32_16x16x32_bf16 v[88:91], v[100:103], v[152:155], 0
    v_mfma_f32_16x16x32_bf16 v[92:95], v[100:103], v[156:159], 0
    s_waitcnt lgkmcnt(0)
    v_mfma_f32_16x16x32_bf16 v[64:67], v[104:107], v[192:195], v[64:67]
    v_mfma_f32_16x16x32_bf16 v[68:71], v[104:107], v[196:199], v[68:71]
    v_mfma_f32_16x16x32_bf16 v[72:75], v[104:107], v[200:203], v[72:75]
    v_mfma_f32_16x16x32_bf16 v[76:79], v[104:107], v[204:207], v[76:79]
    v_mfma_f32_16x16x32_bf16 v[80:83], v[104:107], v[208:211], v[80:83]
    v_mfma_f32_16x16x32_bf16 v[84:87], v[104:107], v[212:215], v[84:87]
    v_mfma_f32_16x16x32_bf16 v[88:91], v[104:107], v[216:219], v[88:91]
    v_mfma_f32_16x16x32_bf16 v[92:95], v[104:107], v[220:223], v[92:95]
    s_mov_b32 exec_lo, 0x00f0000f
    s_mov_b32 exec_hi, 0xf0000f00
    ds_write2_b32 v22, v64, v68 offset0:0 offset1:1
    s_nop 0
    ds_write2_b32 v22, v72, v76 offset0:2 offset1:3
    s_nop 0
    ds_write2_b32 v22, v80, v84 offset0:4 offset1:5
    s_nop 0
    ds_write2_b32 v22, v88, v92 offset0:6 offset1:7
    s_waitcnt lgkmcnt(0)
    s_barrier
    s_branch L_fin
L_f03:
    s_barrier
    s_mov_b32 s51, 0
    v_add_u32 v17, s48, v17
    s_setprio 2
    s_waitcnt vmcnt(0)
    s_sleep 12
    s_add_u32 s83, s51, 0
    s_and_b32 s83, s83, 0xffff
    buffer_load_dwordx4 v[64:67], v17, s[20:23], s83 offen sc1
    s_add_u32 s83, s51, 4096
    s_and_b32 s83, s83, 0xffff
    buffer_load_dwordx4 v[68:71], v17, s[20:23], s83 offen sc1
    s_add_u32 s83, s51, 8192
    s_and_b32 s83, s83, 0xffff
    buffer_load_dwordx4 v[72:75], v17, s[20:23], s83 offen sc1
    s_add_u32 s83, s51, 12288
    s_and_b32 s83, s83, 0xffff
    buffer_load_dwordx4 v[76:79], v17, s[20:23], s83 offen sc1
    s_add_u32 s83, s51, 16384
    s_and_b32 s83, s83, 0xffff
    buffer_load_dwordx4 v[80:83], v17, s[20:23], s83 offen sc1
    s_add_u32 s83, s51, 20480
    s_and_b32 s83, s83, 0xffff
    buffer_load_dwordx4 v[84:87], v17, s[20:23], s83 offen sc1
    s_add_u32 s83, s51, 24576
    s_and_b32 s83, s83, 0xffff
    buffer_load_dwordx4 v[88:91], v17, s[20:23], s83 offen sc1
    s_add_u32 s83, s51, 28672
    s_and_b32 s83, s83, 0xffff
    buffer_load_dwordx4 v[92:95], v17, s[20:23], s83 offen sc1
    s_add_u32 s83, s51, 32768
    s_and_b32 s83, s83, 0xffff
    buffer_load_dwordx4 v[96:99], v17, s[20:23], s83 offen sc1
    s_add_u32 s83, s51, 36864
    s_and_b32 s83, s83, 0xffff
    buffer_load_dwordx4 v[100:103], v17, s[20:23], s83 offen sc1
    s_add_u32 s83, s51, 40960
    s_and_b32 s83, s83, 0xffff
    buffer_load_dwordx4 v[104:107], v17, s[20:23], s83 offen sc1
    s_add_u32 s83, s51, 45056
    s_and_b32 s83, s83, 0xffff
    buffer_load_dwordx4 v[108:111], v17, s[20:23], s83 offen sc1
    s_add_u32 s83, s51, 49152
    s_and_b32 s83, s83, 0xffff
    buffer_load_dwordx4 v[112:115], v17, s[20:23], s83 offen sc1
    s_add_u32 s83, s51, 53248
    s_and_b32 s83, s83, 0xffff
    buffer_load_dwordx4 v[116:119], v17, s[20:23], s83 offen sc1
    s_add_u32 s83, s51, 57344
    s_and_b32 s83, s83, 0xffff
    buffer_load_dwordx4 v[120:123], v17, s[20:23], s83 offen sc1
    s_add_u32 s83, s51, 61440
    s_and_b32 s83, s83, 0xffff
    buffer_load_dwordx4 v[124:127], v17, s[20:23], s83 offen sc1
    v_lshlrev_b32 v21, 2, v1
    s_lshl_b32 s82, s3, 6
    s_add_u32 s82, s82, 9216
    v_and_b32 v4, 31, v1
    v_lshl_add_u32 v22, v4, 1, s82
    v_lshl_add_u32 v23, v3, 4, s82
    v_mov_b32 v48, 3222493025
    s_mov_b32 s50, 0x3f803f80
    v_mfma_f32_16x16x32_bf16 v[8:11], v[28:31], v[44:47], 0
    s_waitcnt vmcnt(15)
    v_mfma_f32_16x16x32_bf16 v[8:11], v[28:31], v[64:67], v[8:11]
    s_waitcnt vmcnt(14)
    v_mfma_f32_16x16x32_bf16 v[8:11], v[28:31], v[68:71], v[8:11]
    s_waitcnt vmcnt(13)
    v_mfma_f32_16x16x32_bf16 v[8:11], v[28:31], v[72:75], v[8:11]
    s_waitcnt vmcnt(12)
    v_mfma_f32_16x16x32_bf16 v[8:11], v[28:31], v[76:79], v[8:11]
    s_waitcnt vmcnt(11)
    v_mfma_f32_16x16x32_bf16 v[8:11], v[28:31], v[80:83], v[8:11]
    s_waitcnt vmcnt(10)
    v_mfma_f32_16x16x32_bf16 v[8:11], v[28:31], v[84:87], v[8:11]
    s_waitcnt vmcnt(9)
    v_mfma_f32_16x16x32_bf16 v[8:11], v[28:31], v[88:91], v[8:11]
    s_waitcnt vmcnt(8)
    v_mfma_f32_16x16x32_bf16 v[8:11], v[28:31], v[92:95], v[8:11]
    s_waitcnt vmcnt(7)
    v_mfma_f32_16x16x32_bf16 v[8:11], v[28:31], v[96:99], v[8:11]
    s_waitcnt vmcnt(6)
    v_mfma_f32_16x16x32_bf16 v[8:11], v[28:31], v[100:103], v[8:11]
    s_waitcnt vmcnt(5)
    v_mfma_f32_16x16x32_bf16 v[8:11], v[28:31], v[104:107], v[8:11]
    s_waitcnt vmcnt(4)
    v_mfma_f32_16x16x32_bf16 v[8:11], v[28:31], v[108:111], v[8:11]
    s_waitcnt vmcnt(3)
    v_mfma_f32_16x16x32_bf16 v[8:11], v[28:31], v[112:115], v[8:11]
    buffer_load_dwordx4 v[192:195], v6, s[36:39], s56 offen offset:0
    buffer_load_dwordx4 v[196:199], v6, s[36:39], s56 offen offset:1024
    buffer_load_dwordx4 v[200:203], v6, s[36:39], s56 offen offset:2048
    buffer_load_dwordx4 v[204:207], v6, s[36:39], s56 offen offset:3072
    buffer_load_dwordx4 v[208:211], v6, s[36:39], s57 offen offset:0
    buffer_load_dwordx4 v[212:215], v6, s[36:39], s57 offen offset:1024
    buffer_load_dwordx4 v[216:219], v6, s[36:39], s57 offen offset:2048
    buffer_load_dwordx4 v[220:223], v6, s[36:39], s57 offen offset:3072
    s_waitcnt vmcnt(10)
    v_mfma_f32_16x16x32_bf16 v[8:11], v[28:31], v[116:119], v[8:11]
    s_waitcnt vmcnt(9)
    v_mfma_f32_16x16x32_bf16 v[8:11], v[28:31], v[120:123], v[8:11]
    s_waitcnt vmcnt(8)
    v_mfma_f32_16x16x32_bf16 v[8:11], v[28:31], v[124:127], v[8:11]
    s_branch L_h4k
L_h4:
    v_mfma_f32_16x16x32_bf16 v[8:11], v[28:31], v[44:47], 0
    v_mfma_f32_16x16x32_bf16 v[8:11], v[28:31], v[64:67], v[8:11]
    v_mfma_f32_16x16x32_bf16 v[8:11], v[28:31], v[68:71], v[8:11]
    v_mfma_f32_16x16x32_bf16 v[8:11], v[28:31], v[72:75], v[8:11]
    v_mfma_f32_16x16x32_bf16 v[8:11], v[28:31], v[76:79], v[8:11]
    v_mfma_f32_16x16x32_bf16 v[8:11], v[28:31], v[80:83], v[8:11]
    v_mfma_f32_16x16x32_bf16 v[8:11], v[28:31], v[84:87], v[8:11]
    v_mfma_f32_16x16x32_bf16 v[8:11], v[28:31], v[88:91], v[8:11]
    v_mfma_f32_16x16x32_bf16 v[8:11], v[28:31], v[92:95], v[8:11]
    v_mfma_f32_16x16x32_bf16 v[8:11], v[28:31], v[96:99], v[8:11]
    v_mfma_f32_16x16x32_bf16 v[8:11], v[28:31], v[100:103], v[8:11]
    v_mfma_f32_16x16x32_bf16 v[8:11], v[28:31], v[104:107], v[8:11]
    v_mfma_f32_16x16x32_bf16 v[8:11], v[28:31], v[108:111], v[8:11]
    v_mfma_f32_16x16x32_bf16 v[8:11], v[28:31], v[112:115], v[8:11]
    v_mfma_f32_16x16x32_bf16 v[8:11], v[28:31], v[116:119], v[8:11]
    v_mfma_f32_16x16x32_bf16 v[8:11], v[28:31], v[120:123], v[8:11]
    v_mfma_f32_16x16x32_bf16 v[8:11], v[28:31], v[124:127], v[8:11]
L_h4k:
    s_nop 6
    s_nop 0
    v_cvt_pk_bf16_f32 v4, v8, v9
    v_cvt_pk_bf16_f32 v5, v10, v11
    v_cmp_u_f32 vcc, v8, v9
    v_cmp_u_f32 s[60:61], v10, v11
    ds_write_b64 v19, v[4:5]
    s_or_b64 vcc, vcc, s[60:61]
    s_cbranch_vccz L_h4ok
    s_sleep 2
    s_add_u32 s83, s51, 0
    s_and_b32 s83, s83, 0xffff
    buffer_load_dwordx4 v[64:67], v17, s[20:23], s83 offen sc1
    s_add_u32 s83, s51, 4096
    s_and_b32 s83, s83, 0xffff
    buffer_load_dwordx4 v[68:71], v17, s[20:23], s83 offen sc1
    s_add_u32 s83, s51, 8192
    s_and_b32 s83, s83, 0xffff
    buffer_load_dwordx4 v[72:75], v17, s[20:23], s83 offen sc1
    s_add_u32 s83, s51, 12288
    s_and_b32 s83, s83, 0xffff
    buffer_load_dwordx4 v[76:79], v17, s[20:23], s83 offen sc1
    s_add_u32 s83, s51, 16384
    s_and_b32 s83, s83, 0xffff
    buffer_load_dwordx4 v[80:83], v17, s[20:23], s83 offen sc1
    s_add_u32 s83, s51, 20480
    s_and_b32 s83, s83, 0xffff
    buffer_load_dwordx4 v[84:87], v17, s[20:23], s83 offen sc1
    s_add_u32 s83, s51, 24576
    s_and_b32 s83, s83, 0xffff
    buffer_load_dwordx4 v[88:91], v17, s[20:23], s83 offen sc1
    s_add_u32 s83, s51, 28672
    s_and_b32 s83, s83, 0xffff
    buffer_load_dwordx4 v[92:95], v17, s[20:23], s83 offen sc1
    s_add_u32 s83, s51, 32768
    s_and_b32 s83, s83, 0xffff
    buffer_load_dwordx4 v[96:99], v17, s[20:23], s83 offen sc1
    s_add_u32 s83, s51, 36864
    s_and_b32 s83, s83, 0xffff
    buffer_load_dwordx4 v[100:103], v17, s[20:23], s83 offen sc1
    s_add_u32 s83, s51, 40960
    s_and_b32 s83, s83, 0xffff
    buffer_load_dwordx4 v[104:107], v17, s[20:23], s83 offen sc1
    s_add_u32 s83, s51, 45056
    s_and_b32 s83, s83, 0xffff
    buffer_load_dwordx4 v[108:111], v17, s[20:23], s83 offen sc1
    s_add_u32 s83, s51, 49152
    s_and_b32 s83, s83, 0xffff
    buffer_load_dwordx4 v[112:115], v17, s[20:23], s83 offen sc1
    s_add_u32 s83, s51, 53248
    s_and_b32 s83, s83, 0xffff
    buffer_load_dwordx4 v[116:119], v17, s[20:23], s83 offen sc1
    s_add_u32 s83, s51, 57344
    s_and_b32 s83, s83, 0xffff
    buffer_load_dwordx4 v[120:123], v17, s[20:23], s83 offen sc1
    s_add_u32 s83, s51, 61440
    s_and_b32 s83, s83, 0xffff
    buffer_load_dwordx4 v[124:127], v17, s[20:23], s83 offen sc1
    s_waitcnt vmcnt(0)
    s_add_u32 s65, s65, 1
    s_cmp_lt_u32 s65, 200000
    s_cbranch_scc1 L_h4
    v_mov_b32 v4, 4
    v_mov_b32 v5, 0
    buffer_store_dword v4, v5, s[44:47], 0 offen offset:16
L_h4ok:
    s_waitcnt lgkmcnt(0)
    s_barrier
    s_setprio 0
    ds_read_b128 v[32:35], v7 offset:8192
    ds_read_b32 v100, v21 offset:2048
    ds_read_b32 v101, v21 offset:2304
    ds_read_b32 v102, v21 offset:2560
    ds_read_b32 v103, v21 offset:2816
    ds_read_b32 v104, v21 offset:3072
    ds_read_b32 v105, v21 offset:3328
    ds_read_b32 v106, v21 offset:3584
    ds_read_b32 v107, v21 offset:3840
    v_lshrrev_b32 v4, 3, v2
    v_lshl_add_u32 v4, v3, 1, v4
    v_lshlrev_b32 v4, 10, v4
    v_and_b32 v5, 7, v2
    v_lshl_add_u32 v16, v5, 4, v4
    s_lshl_b32 s58, s80, 16
    s_lshl_b32 s83, s81, 7
    s_add_u32 s58, s58, s83
    s_add_u32 s58, s58, 7602176
    s_and_b32 s82, s83, 0x3ff
    s_add_u32 s82, s82, 8192
    v_lshl_add_u32 v19, v5, 4, s82
    ds_read_b128 v[44:47], v19
    v_and_b32 v4, 1, v3
    v_lshlrev_b32 v4, 3, v4
    v_lshl_add_u32 v18, v5, 4, v4
    s_lshl_b32 s57, s80, 10
    s_add_u32 s57, s57, s83
    s_waitcnt lgkmcnt(9)
    v_dot2_f32_bf16 v40, v32, s50, 0
    v_dot2_f32_bf16 v41, v32, v32, 0
    v_dot2_f32_bf16 v40, v33, s50, v40
    v_dot2_f32_bf16 v41, v33, v33, v41
    v_dot2_f32_bf16 v40, v34, s50, v40
    v_dot2_f32_bf16 v41, v34, v34, v41
    v_dot2_f32_bf16 v40, v35, s50, v40
    v_dot2_f32_bf16 v41, v35, v35, v41
    s_mov_b32 s48, 0xff
    s_mov_b32 s49, 0
    s_mov_b32 s65, 0
    s_waitcnt lgkmcnt(0)
    v_add_f32_dpp v40, v40, v40 quad_perm:[1,0,3,2] row_mask:0xf bank_mask:0xf
    v_add_f32_dpp v41, v41, v41 quad_perm:[1,0,3,2] row_mask:0xf bank_mask:0xf
    v_pk_add_f32 v[100:101], v[100:101], v[102:103]
    v_add_f32_dpp v40, v40, v40 quad_perm:[2,3,0,1] row_mask:0xf bank_mask:0xf
    v_add_f32_dpp v41, v41, v41 quad_perm:[2,3,0,1] row_mask:0xf bank_mask:0xf
    v_pk_add_f32 v[104:105], v[104:105], v[106:107]
    v_add_f32_dpp v40, v40, v40 row_half_mirror row_mask:0xf bank_mask:0xf
    v_add_f32_dpp v41, v41, v41 row_half_mirror row_mask:0xf bank_mask:0xf
    v_pk_add_f32 v[100:101], v[100:101], v[104:105]
    v_add_f32_dpp v40, v40, v40 row_mirror row_mask:0xf bank_mask:0xf
    v_add_f32_dpp v41, v41, v41 row_mirror row_mask:0xf bank_mask:0xf
    v_add_f32 v100, v100, v101
    v_mov_b32 v42, v40
    v_mov_b32 v43, v41
    s_nop 0
    v_permlane16_swap_b32 v40, v42
    v_permlane16_swap_b32 v41, v43
    v_add_f32 v40, v40, v42
    v_add_f32 v41, v41, v43
    v_mov_b32 v42, v40
    v_mov_b32 v43, v41
    s_nop 0
    v_permlane32_swap_b32 v40, v42
    v_permlane32_swap_b32 v41, v43
    v_add_f32 v40, v40, v42
    v_add_f32 v41, v41, v43
    v_mul_f32 v40, 3137339392, v40
    v_mul_f32 v41, 989855744, v41
    v_fma_f32 v41, -v40, v40, v41
    v_max_f32 v41, 0, v41
    v_add_f32 v41, 925353388, v41
    v_rsq_f32 v41, v41
    s_nop 0
    v_mul_f32 v40, v40, v41
    v_mul_f32 v40, v40, v100
    v_cndmask_b32 v44, 0, v44, s[48:49]
    v_cndmask_b32 v45, 0, v45, s[48:49]
    v_cndmask_b32 v46, 0, v46, s[48:49]
    v_cndmask_b32 v47, 0, v47, s[48:49]
    s_setprio 1
    s_barrier
    ds_read_b32 v32, v21 offset:0
    ds_read_b32 v33, v21 offset:256
    ds_read_b32 v34, v21 offset:512
    ds_read_b32 v35, v21 offset:768
    ds_read_b32 v36, v21 offset:1024
    ds_read_b32 v37, v21 offset:1280
    ds_read_b32 v38, v21 offset:1536
    ds_read_b32 v39, v21 offset:1792
    s_waitcnt vmcnt(0)
    v_perm_b32 v128, v196, v192, s77
    v_perm_b32 v132, v196, v192, s78
    v_perm_b32 v129, v204, v200, s77
    v_perm_b32 v133, v204, v200, s78
    v_perm_b32 v130, v212, v208, s77
    v_perm_b32 v134, v212, v208, s78
    v_perm_b32 v131, v220, v216, s77
    v_perm_b32 v135, v220, v216, s78
    v_perm_b32 v136, v197, v193, s77
    v_perm_b32 v140, v197, v193, s78
    v_perm_b32 v137, v205, v201, s77
    v_perm_b32 v141, v205, v201, s78
    v_perm_b32 v138, v213, v209, s77
    v_perm_b32 v142, v213, v209, s78
    s_waitcnt lgkmcnt(4)
    v_pk_add_f32 v[32:33], v[32:33], v[34:35]
    s_waitcnt lgkmcnt(0)
    v_pk_add_f32 v[36:37], v[36:37], v[38:39]
    v_pk_add_f32 v[32:33], v[32:33], v[36:37]
    v_add_f32 v24, v32, v33
    v_fma_f32 v24, v24, v41, v40
    v_mov_b32 v25, v24
    s_nop 1
    v_permlane32_swap_b32 v24, v25
    v_mul_f32 v26, v24, v24
    v_mul_f32 v25, v24, v25
    v_fmamk_f32 v26, v26, 3184710632, v48
    v_mul_f32 v26, v26, v24
    v_exp_f32 v26, v26
    s_nop 0
    v_add_f32 v26, 1.0, v26
    v_rcp_f32 v26, v26
    s_nop 0
    v_mul_f32 v26, v26, v25
    v_cvt_pk_bf16_f32 v26, v26, v26
    ds_write_b16 v22, v26
    ds_read_b128 v[32:35], v23
    v_perm_b32 v139, v221, v217, s77
    v_perm_b32 v143, v221, v217, s78
    v_perm_b32 v144, v198, v194, s77
    v_perm_b32 v148, v198, v194, s78
    v_perm_b32 v145, v206, v202, s77
    v_perm_b32 v149, v206, v202, s78
    v_perm_b32 v146, v214, v210, s77
    v_perm_b32 v150, v214, v210, s78
    v_perm_b32 v147, v222, v218, s77
    v_perm_b32 v151, v222, v218, s78
    v_perm_b32 v152, v199, v195, s77
    v_perm_b32 v156, v199, v195, s78
    v_perm_b32 v153, v207, v203, s77
    v_perm_b32 v157, v207, v203, s78
    v_perm_b32 v154, v215, v211, s77
    v_perm_b32 v158, v215, v211, s78
    v_perm_b32 v155, v223, v219, s77
    v_perm_b32 v159, v223, v219, s78
    s_waitcnt lgkmcnt(0)
    v_mfma_f32_16x16x32_bf16 v[64:67], v[32:35], v[128:131], 0
    v_mfma_f32_16x16x32_bf16 v[68:71], v[32:35], v[132:135], 0
    v_mfma_f32_16x16x32_bf16 v[72:75], v[32:35], v[136:139], 0
    v_mfma_f32_16x16x32_bf16 v[76:79], v[32:35], v[140:143], 0
    v_mfma_f32_16x16x32_bf16 v[80:83], v[32:35], v[144:147], 0
    v_mfma_f32_16x16x32_bf16 v[84:87], v[32:35], v[148:151], 0
    v_mfma_f32_16x16x32_bf16 v[88:91], v[32:35], v[152:155], 0
    v_mfma_f32_16x16x32_bf16 v[92:95], v[32:35], v[156:159], 0
    s_mov_b64 exec, 0xffff
    s_nop 0
    v_cvt_pk_bf16_f32 v8, v64, v68
    s_nop 0
    v_cvt_pk_bf16_f32 v9, v72, v76
    s_nop 0
    v_cvt_pk_bf16_f32 v10, v80, v84
    s_nop 0
    v_cvt_pk_bf16_f32 v11, v88, v92
    buffer_store_dwordx4 v[8:11], v7, s[20:23], s59 offen sc1
    s_mov_b64 exec, -1
    s_cmp_ge_u32 s81, 8
    s_cbranch_scc1 L_fin
    s_cmp_lg_u32 s3, 0
    s_cbranch_scc1 L_fin
    s_waitcnt vmcnt(0)
L_h5:
    s_add_u32 s83, s58, 0
    buffer_load_dwordx4 v[64:67], v16, s[20:23], s83 offen sc1
    s_add_u32 s83, s58, 8192
    buffer_load_dwordx4 v[68:71], v16, s[20:23], s83 offen sc1
    s_add_u32 s83, s58, 16384
    buffer_load_dwordx4 v[72:75], v16, s[20:23], s83 offen sc1
    s_add_u32 s83, s58, 24576
    buffer_load_dwordx4 v[76:79], v16, s[20:23], s83 offen sc1
    s_add_u32 s83, s58, 32768
    buffer_load_dwordx4 v[80:83], v16, s[20:23], s83 offen sc1
    s_add_u32 s83, s58, 40960
    buffer_load_dwordx4 v[84:87], v16, s[20:23], s83 offen sc1
    s_add_u32 s83, s58, 49152
    buffer_load_dwordx4 v[88:91], v16, s[20:23], s83 offen sc1
    v_mfma_f32_16x16x32_bf16 v[8:11], v[28:31], v[44:47], 0
    s_waitcnt vmcnt(6)
    v_mfma_f32_16x16x32_bf16 v[8:11], v[28:31], v[64:67], v[8:11]
    s_waitcnt vmcnt(5)
    v_mfma_f32_16x16x32_bf16 v[8:11], v[28:31], v[68:71], v[8:11]
    s_waitcnt vmcnt(4)
    v_mfma_f32_16x16x32_bf16 v[8:11], v[28:31], v[72:75], v[8:11]
    s_waitcnt vmcnt(3)
    v_mfma_f32_16x16x32_bf16 v[8:11], v[28:31], v[76:79], v[8:11]
    s_waitcnt vmcnt(2)
    v_mfma_f32_16x16x32_bf16 v[8:11], v[28:31], v[80:83], v[8:11]
    s_waitcnt vmcnt(1)
    v_mfma_f32_16x16x32_bf16 v[8:11], v[28:31], v[84:87], v[8:11]
    s_waitcnt vmcnt(0)
    v_mfma_f32_16x16x32_bf16 v[8:11], v[28:31], v[88:91], v[8:11]
    s_nop 7
    v_add_f32_dpp v8, v8, v8 row_ror:8 row_mask:0xf bank_mask:0xf
    v_add_f32_dpp v9, v9, v9 row_ror:8 row_mask:0xf bank_mask:0xf
    v_add_f32_dpp v10, v10, v10 row_ror:8 row_mask:0xf bank_mask:0xf
    v_add_f32_dpp v11, v11, v11 row_ror:8 row_mask:0xf bank_mask:0xf
    v_cmp_u_f32 vcc, v8, v9
    v_cmp_u_f32 s[60:61], v10, v11
    v_cvt_pk_bf16_f32 v24, v8, v9
    v_cvt_pk_bf16_f32 v25, v10, v11
    s_or_b64 vcc, vcc, s[60:61]
    s_cbranch_vccz L_h5ok
    s_sleep 2
    s_add_u32 s65, s65, 1
    s_cmp_lt_u32 s65, 200000
    s_cbranch_scc1 L_h5
    v_mov_b32 v4, 5
    v_mov_b32 v5, 0
    buffer_store_dword v4, v5, s[44:47], 0 offen offset:20
L_h5ok:
    s_mov_b32 exec_lo, 0x00ff00ff
    s_mov_b32 exec_hi, 0
    buffer_store_dwordx2 v[24:25], v18, s[40:43], s57 offen
    s_cmp_lg_u32 s2, 0
    s_cbranch_scc1 L_fin
    s_mov_b64 exec, 1
    v_mov_b32 v4, s63
    v_mov_b32 v5, 0
    buffer_store_dword v4, v5, s[20:23], 0 offen sc1
L_fin:
L_end:
    s_endpgm
L_codeend:
.section .rodata,"a"
.p2align 6
.amdhsa_kernel sequential_preLN__compressed_kv_cla__geglu_ffn__decode_kernel
  .amdhsa_next_free_vgpr 256
  .amdhsa_next_free_sgpr 102
  .amdhsa_accum_offset 256
  .amdhsa_group_segment_fixed_size 0
  .amdhsa_kernarg_size 104
  .amdhsa_user_sgpr_count 2
  .amdhsa_user_sgpr_kernarg_segment_ptr 1
  .amdhsa_system_sgpr_workgroup_id_x 1
  .amdhsa_float_denorm_mode_32 3
.end_amdhsa_kernel
```
